```python
import torch

def _softmax(x, axis=-1):
    return torch.softmax(x, dim=axis)
def _gelu(x):
    return torch.nn.functional.gelu(x, approximate="tanh")
def _silu(x):
    return torch.nn.functional.silu(x)
def _sigmoid(x):
    return torch.sigmoid(x)
def _layernorm(x, axis=-1, eps=1e-5):
    m = x.mean(dim=axis, keepdim=True)
    v = x.var(dim=axis, keepdim=True, unbiased=False)
    return (x - m) / torch.sqrt(v + eps)
def _scatter_add(tgt, idx, src, axis=0):
    return tgt.clone().index_add_(axis, idx, src)
def _segment_sum(src, seg, n):
    out = torch.zeros((n,) + src.shape[1:], dtype=src.dtype)
    return out.index_add_(0, seg, src)
def _pad(x, pw):
    flat = tuple(v for pair in reversed(pw) for v in pair)
    return torch.nn.functional.pad(x, flat)

kernel_name = 'recurrent_scan__sliding_block_cached__glu_gated_swiglu__decode'

def setup_inputs():

    _w = (lambda a: (lambda t: t.to(torch.bfloat16) if t.is_floating_point() else t)(torch.as_tensor(a)))
    def _A_setup():
        B, Sq, D = 1, 1, 640
        Hq, Hkv, Sk, Dh = 32, 32, 32768, 192
        assert Hq % Hkv == 0, (Hq, Hkv)
        return {
            "x": _w((lambda *s: torch.randn(*s, dtype=torch.bfloat16) * 0.05)(B, Sq, D)),
            "k_cache": _w((lambda *s: torch.randn(*s, dtype=torch.bfloat16) * 3.2)(B, Hkv, Sk, Dh)),
            "v_cache": _w((lambda *s: torch.randn(*s, dtype=torch.bfloat16) * 3.2)(B, Hkv, Sk, Dh)),
            "wq": _w((lambda *s: torch.randn(*s, dtype=torch.bfloat16) * 3.2)(D, Hq * Dh) * (D ** -0.5)),
            "wo": _w((lambda *s: torch.randn(*s, dtype=torch.bfloat16) * 3.2)(Hq * Dh, D) * ((Hq * Dh) ** -0.5)),
        }
    _A_in = _A_setup()

    def _B_setup():
        B, S, D, F = 1, 1, 640, 1536
        return {
            "x": _w((lambda *s: torch.randn(*s, dtype=torch.bfloat16) * 0.05)(B, S, D)),
            "w1": _w((lambda *s: torch.randn(*s, dtype=torch.bfloat16) * 0.4)(D, F) * (2.0 / D) ** 0.5),
            "w3": _w((lambda *s: torch.randn(*s, dtype=torch.bfloat16) * 0.4)(D, F) * (2.0 / D) ** 0.5),
            "w2": _w((lambda *s: torch.randn(*s, dtype=torch.bfloat16) * 0.4)(F, D) * (2.0 / F) ** 0.5),
        }
    _B_in = _B_setup()

    return {
        "A_x": _A_in["x"],
        "A_k_cache": _A_in["k_cache"],
        "A_v_cache": _A_in["v_cache"],
        "A_wq": _A_in["wq"],
        "A_wo": _A_in["wo"],
        "B_x": _B_in["x"],
        "B_w1": _B_in["w1"],
        "B_w3": _B_in["w3"],
        "B_w2": _B_in["w2"],
    }

def reference(A_x, A_k_cache, A_v_cache, A_wq, A_wo, B_x, B_w1, B_w3, B_w2):
    def _A_ref(x, k_cache, v_cache, wq, wo):
        B, Sq, D = x.shape
        Hq, Dh = 32, 192
        Hkv, Sk = k_cache.shape[1], k_cache.shape[2]
        W = min(4096, max(256, Sk // 4))
        rep = Hq // Hkv
        q = (lambda x, *d: x.permute(*d))((x @ wq).reshape(B, Sq, Hq, Dh), 0, 2, 1, 3)
        k = (lambda x, n, axis: torch.repeat_interleave(x, n, dim=axis))(k_cache[:, :, Sk - W:, :], rep, axis=1)
        v = (lambda x, n, axis: torch.repeat_interleave(x, n, dim=axis))(v_cache[:, :, Sk - W:, :], rep, axis=1)
        scores = torch.einsum("bhqd,bhkd->bhqk", q, k) * (Dh ** -0.5)
        p = _softmax(scores, axis=-1)
        o = torch.einsum("bhqk,bhkd->bhqd", p, v)
        return (lambda x, *d: x.permute(*d))(o, 0, 2, 1, 3).reshape(B, Sq, Hq * Dh) @ wo

    def _B_ref(x, w1, w3, w2):
        gate = torch.einsum("bsd,df->bsf", x, w1)
        up = torch.einsum("bsd,df->bsf", x, w3)
        h = _silu(gate) * up
        out = torch.einsum("bsf,fd->bsd", h, w2)
        return out

    x = A_x
    xn = _layernorm(x, axis=-1)
    s = _A_ref(xn, A_k_cache, A_v_cache, A_wq, A_wo)
    g = _silu(_B_ref(xn, B_w1, B_w3, B_w2))
    return x + s * g
```

```asm
; @launch grid=(256,1,1) block=(768,1,1) lds=11008
.amdgcn_target "amdgcn-amd-amdhsa--gfx950"
.text
.p2align 12
.globl recurrent_scan__sliding_block_cached__glu_gated_swiglu__decode_kernel
.p2align 8
.type recurrent_scan__sliding_block_cached__glu_gated_swiglu__decode_kernel,@function
recurrent_scan__sliding_block_cached__glu_gated_swiglu__decode_kernel:
s_load_dwordx16 s[4:19], s[0:1], 0
s_load_dwordx8 s[20:27], s[0:1], 64
s_cmpk_ge_u32 s2, 256
s_cbranch_scc1 L_end
v_lshrrev_b32 v2, 6, v0
v_and_b32 v1, 63, v0
v_readfirstlane_b32 s28, v2
v_lshrrev_b32 v45, 3, v1
v_and_b32 v46, 7, v1
s_and_b32 s30, s2, 31
s_lshr_b32 s31, s2, 5
s_cmp_gt_u32 s28, 2
s_cbranch_scc1 L_w3up
s_setprio 3
s_mul_i32 s51, s31, 983040
s_mul_i32 s56, s30, 3
s_add_u32 s56, s56, s28
s_lshl_b32 s56, s56, 7
s_add_u32 s56, s56, s51
v_mul_u32_u24 v8, 12288, v45
v_lshl_add_u32 v8, v46, 4, v8
s_mov_b32 s42, 7864320
s_mov_b32 s43, 0x20000
s_waitcnt lgkmcnt(0)
s_mov_b64 s[40:41], s[10:11]
buffer_load_dwordx4 v[48:51], v8, s[40:43], s56 offen nt
s_add_u32 s56, s56, 98304
buffer_load_dwordx4 v[52:55], v8, s[40:43], s56 offen nt
s_add_u32 s56, s56, 98304
buffer_load_dwordx4 v[56:59], v8, s[40:43], s56 offen nt
s_add_u32 s56, s56, 98304
buffer_load_dwordx4 v[60:63], v8, s[40:43], s56 offen nt
s_add_u32 s56, s56, 98304
buffer_load_dwordx4 v[64:67], v8, s[40:43], s56 offen nt
s_add_u32 s56, s56, 98304
buffer_load_dwordx4 v[68:71], v8, s[40:43], s56 offen nt
s_add_u32 s56, s56, 98304
buffer_load_dwordx4 v[72:75], v8, s[40:43], s56 offen nt
s_add_u32 s56, s56, 98304
buffer_load_dwordx4 v[76:79], v8, s[40:43], s56 offen nt
s_add_u32 s56, s56, 98304
buffer_load_dwordx4 v[80:83], v8, s[40:43], s56 offen nt
s_add_u32 s56, s56, 98304
buffer_load_dwordx4 v[84:87], v8, s[40:43], s56 offen nt
s_barrier
s_load_dword s29, s[26:27], 0
s_load_dword s3, s[4:5], 0
s_branch L_h012b
L_w3up:
s_cmp_gt_u32 s28, 3
s_cbranch_scc1 L_main
s_setprio 3
s_lshr_b32 s49, s2, 3
s_mul_i32 s66, s49, 26
s_lshr_b32 s66, s66, 8
s_mul_i32 s51, s66, 10
s_sub_u32 s49, s49, s51
s_and_b32 s51, s2, 7
s_mul_i32 s51, s51, 3
s_add_u32 s48, s51, s66
s_mul_i32 s51, s49, 196608
s_lshl_b32 s56, s48, 7
s_add_u32 s56, s56, s51
v_mul_u32_u24 v8, 3072, v45
v_lshl_add_u32 v8, v46, 4, v8
s_mov_b32 s42, 1966080
s_mov_b32 s43, 0x20000
s_mov_b32 s46, 1966080
s_mov_b32 s47, 0x20000
s_waitcnt lgkmcnt(0)
s_load_dword s29, s[26:27], 0
s_load_dword s3, s[4:5], 0
s_cmpk_ge_u32 s2, 240
s_cbranch_scc1 L_h3skip
s_mov_b64 s[40:41], s[16:17]
s_mov_b64 s[44:45], s[18:19]
buffer_load_dwordx4 v[48:51], v8, s[40:43], s56 offen nt
buffer_load_dwordx4 v[52:55], v8, s[44:47], s56 offen nt
s_addk_i32 s56, 24576
buffer_load_dwordx4 v[56:59], v8, s[40:43], s56 offen nt
buffer_load_dwordx4 v[60:63], v8, s[44:47], s56 offen nt
s_addk_i32 s56, 24576
buffer_load_dwordx4 v[64:67], v8, s[40:43], s56 offen nt
buffer_load_dwordx4 v[68:71], v8, s[44:47], s56 offen nt
s_addk_i32 s56, 24576
buffer_load_dwordx4 v[72:75], v8, s[40:43], s56 offen nt
buffer_load_dwordx4 v[76:79], v8, s[44:47], s56 offen nt
s_addk_i32 s56, 24576
buffer_load_dwordx4 v[80:83], v8, s[40:43], s56 offen nt
buffer_load_dwordx4 v[84:87], v8, s[44:47], s56 offen nt
s_addk_i32 s56, 24576
s_barrier
buffer_load_dwordx4 v[88:91], v8, s[40:43], s56 offen nt
buffer_load_dwordx4 v[92:95], v8, s[44:47], s56 offen nt
s_addk_i32 s56, 24576
buffer_load_dwordx4 v[96:99], v8, s[40:43], s56 offen nt
buffer_load_dwordx4 v[100:103], v8, s[44:47], s56 offen nt
s_addk_i32 s56, 24576
buffer_load_dwordx4 v[104:107], v8, s[40:43], s56 offen nt
buffer_load_dwordx4 v[108:111], v8, s[44:47], s56 offen nt
s_branch L_h3b
L_h3skip:
s_barrier
s_branch L_h3i
L_main:
s_setprio 2
v_mov_b32 v36, 0
s_cmp_lg_u32 s28, 5
s_cbranch_scc1 L_nopf
s_getpc_b64 s[52:53]
L_pfbase:
s_lshr_b32 s51, s2, 3
s_lshl_b32 s51, s51, 7
v_and_b32 v2, 3, v1
v_lshl_add_u32 v2, v2, 12, s51
v_min_u32 v2, L_code_end-L_pfbase-4, v2
global_load_dword v47, v2, s[52:53]
L_nopf:
v_lshlrev_b32 v3, 2, v1
ds_write2st64_b32 v3, v36, v36 offset1:1
s_and_b32 s51, s28, 3
s_lshl_b32 s51, s51, 3
s_add_u32 s51, s51, s31
s_lshr_b32 s52, s28, 3
s_lshl_b32 s52, s52, 8
s_lshl_b32 s53, s30, 8
s_xor_b32 s52, s52, s53
s_and_b32 s52, s52, 256
s_add_u32 s56, s51, s52
s_mulk_i32 s56, 3072
s_mul_i32 s54, s30, 12582912
s_add_u32 s54, s54, 11010048
v_mul_u32_u24 v2, 384, v45
v_lshl_add_u32 v2, v46, 4, v2
s_mov_b32 s38, 1572864
s_mov_b32 s39, 0x20000
s_waitcnt lgkmcnt(0)
s_cmp_lg_u32 s28, 8
s_cbranch_scc1 L_nox
s_mov_b64 s[40:41], s[4:5]
s_mov_b32 s42, 1280
s_mov_b32 s43, 0x20000
v_lshlrev_b32 v8, 4, v1
s_barrier
s_setprio 3
buffer_load_dwordx4 v[20:23], v8, s[40:43], 0 offen
buffer_load_dword v24, v3, s[40:43], 0 offen offset:1024
s_setprio 2
s_branch L_ln
L_nox:
s_barrier
L_lnback:
s_add_u32 s36, s6, s54
s_addc_u32 s37, s7, 0
s_load_dword s29, s[26:27], 0
s_load_dword s3, s[4:5], 0
buffer_load_dwordx4 v[48:51], v2, s[36:39], s56 offen offset:0 nt
s_add_u32 s51, s51, 9
s_add_u32 s52, s52, 32
buffer_load_dwordx4 v[52:55], v2, s[36:39], s56 offen offset:128 nt
s_and_b32 s53, s51, 31
s_add_u32 s57, s53, s52
buffer_load_dwordx4 v[56:59], v2, s[36:39], s56 offen offset:256 nt
s_mulk_i32 s57, 3072
buffer_load_dwordx4 v[60:63], v2, s[36:39], s57 offen offset:0 nt
s_add_u32 s51, s51, 9
s_add_u32 s52, s52, 32
buffer_load_dwordx4 v[64:67], v2, s[36:39], s57 offen offset:128 nt
s_and_b32 s53, s51, 31
s_add_u32 s58, s53, s52
buffer_load_dwordx4 v[68:71], v2, s[36:39], s57 offen offset:256 nt
s_mulk_i32 s58, 3072
buffer_load_dwordx4 v[72:75], v2, s[36:39], s58 offen offset:0 nt
s_add_u32 s51, s51, 9
s_add_u32 s52, s52, 32
buffer_load_dwordx4 v[76:79], v2, s[36:39], s58 offen offset:128 nt
s_and_b32 s53, s51, 31
s_add_u32 s59, s53, s52
buffer_load_dwordx4 v[80:83], v2, s[36:39], s58 offen offset:256 nt
s_mulk_i32 s59, 3072
buffer_load_dwordx4 v[84:87], v2, s[36:39], s59 offen offset:0 nt
s_add_u32 s51, s51, 9
s_add_u32 s52, s52, 32
buffer_load_dwordx4 v[88:91], v2, s[36:39], s59 offen offset:128 nt
s_and_b32 s53, s51, 31
s_add_u32 s60, s53, s52
buffer_load_dwordx4 v[92:95], v2, s[36:39], s59 offen offset:256 nt
s_mulk_i32 s60, 3072
buffer_load_dwordx4 v[96:99], v2, s[36:39], s60 offen offset:0 nt
s_add_u32 s51, s51, 9
s_add_u32 s52, s52, 32
buffer_load_dwordx4 v[100:103], v2, s[36:39], s60 offen offset:128 nt
s_and_b32 s53, s51, 31
s_add_u32 s61, s53, s52
buffer_load_dwordx4 v[104:107], v2, s[36:39], s60 offen offset:256 nt
s_mulk_i32 s61, 3072
buffer_load_dwordx4 v[108:111], v2, s[36:39], s61 offen offset:0 nt
s_add_u32 s51, s51, 9
s_add_u32 s52, s52, 32
buffer_load_dwordx4 v[112:115], v2, s[36:39], s61 offen offset:128 nt
s_and_b32 s53, s51, 31
s_add_u32 s62, s53, s52
buffer_load_dwordx4 v[116:119], v2, s[36:39], s61 offen offset:256 nt
s_mulk_i32 s62, 3072
buffer_load_dwordx4 v[120:123], v2, s[36:39], s62 offen offset:0 nt
s_add_u32 s51, s51, 9
s_add_u32 s52, s52, 32
buffer_load_dwordx4 v[124:127], v2, s[36:39], s62 offen offset:128 nt
s_and_b32 s53, s51, 31
s_add_u32 s63, s53, s52
buffer_load_dwordx4 v[128:131], v2, s[36:39], s62 offen offset:256 nt
s_mulk_i32 s63, 3072
buffer_load_dwordx4 v[132:135], v2, s[36:39], s63 offen offset:0 nt
s_add_u32 s40, s8, s54
s_addc_u32 s41, s9, 0
buffer_load_dwordx4 v[136:139], v2, s[36:39], s63 offen offset:128 nt
s_mov_b32 s42, 1572864
s_mov_b32 s43, 0x20000
buffer_load_dwordx4 v[140:143], v2, s[36:39], s63 offen offset:256 nt
s_setprio 3
s_mov_b64 s[32:33], s[26:27]
s_mov_b32 s34, 704512
s_mov_b32 s35, 0x20000
v_and_b32 v3, 1, v1
v_lshlrev_b32 v3, 4, v3
v_mov_b32 v7, 0xffff
v_lshlrev_b32 v3, v3, v7
v_bfe_u32 v7, v1, 1, 2
v_cmp_eq_u32 vcc, 0, v7
v_cmp_eq_u32 s[92:93], 1, v7
v_cmp_eq_u32 s[94:95], 2, v7
v_cndmask_b32 v4, 0, v3, vcc
v_cmp_eq_u32 vcc, 3, v7
v_cndmask_b32 v5, 0, v3, s[92:93]
v_cndmask_b32 v6, 0, v3, s[94:95]
v_cndmask_b32 v7, 0, v3, vcc
s_mov_b32 s14, 0x00ff00ff
s_mov_b32 s15, s14
v_lshlrev_b32 v37, 4, v46
v_mov_b32 v8, 0
v_mov_b32 v9, 0
v_mov_b32 v10, 0
v_mov_b32 v11, 0
v_mov_b32 v12, 0
v_mov_b32 v13, 0
v_mov_b32 v14, 0
v_mov_b32 v15, 0
s_mov_b32 s50, 8388608
L_mq:
ds_read_b32 v38, v36 offset:0
ds_read_b128 v[16:19], v37 offset:512
ds_read_b128 v[20:23], v37 offset:640
ds_read_b128 v[24:27], v37 offset:768
s_waitcnt lgkmcnt(0)
v_cmp_ne_u32 vcc, 3, v38
s_cbranch_vccz L_mq_ok
s_sleep 1
s_sub_u32 s50, s50, 1
s_cbranch_scc0 L_mq
L_mq_ok:
s_mul_i32 s67, s3, 0x9e3779b1
s_lshr_b32 s67, s67, 2
s_bitset1_b32 s67, 30
s_add_u32 s29, s29, s67
s_and_b32 s29, s29, -16
s_waitcnt vmcnt(18)
v_dot2c_f32_bf16 v8, v48, v16
v_dot2c_f32_bf16 v9, v60, v16
v_dot2c_f32_bf16 v8, v49, v17
v_dot2c_f32_bf16 v9, v61, v17
v_dot2c_f32_bf16 v8, v50, v18
v_dot2c_f32_bf16 v9, v62, v18
v_dot2c_f32_bf16 v8, v51, v19
v_dot2c_f32_bf16 v9, v63, v19
v_dot2c_f32_bf16 v8, v52, v20
v_dot2c_f32_bf16 v9, v64, v20
v_dot2c_f32_bf16 v8, v53, v21
v_dot2c_f32_bf16 v9, v65, v21
v_dot2c_f32_bf16 v8, v54, v22
v_dot2c_f32_bf16 v9, v66, v22
v_dot2c_f32_bf16 v8, v55, v23
v_dot2c_f32_bf16 v9, v67, v23
v_dot2c_f32_bf16 v8, v56, v24
v_dot2c_f32_bf16 v9, v68, v24
v_dot2c_f32_bf16 v8, v57, v25
v_dot2c_f32_bf16 v9, v69, v25
v_dot2c_f32_bf16 v8, v58, v26
v_dot2c_f32_bf16 v9, v70, v26
v_dot2c_f32_bf16 v8, v59, v27
v_dot2c_f32_bf16 v9, v71, v27
s_waitcnt vmcnt(12)
v_dot2c_f32_bf16 v10, v72, v16
v_dot2c_f32_bf16 v11, v84, v16
v_dot2c_f32_bf16 v10, v73, v17
v_dot2c_f32_bf16 v11, v85, v17
v_dot2c_f32_bf16 v10, v74, v18
v_dot2c_f32_bf16 v11, v86, v18
v_dot2c_f32_bf16 v10, v75, v19
v_dot2c_f32_bf16 v11, v87, v19
v_dot2c_f32_bf16 v10, v76, v20
v_dot2c_f32_bf16 v11, v88, v20
v_dot2c_f32_bf16 v10, v77, v21
v_dot2c_f32_bf16 v11, v89, v21
v_dot2c_f32_bf16 v10, v78, v22
v_dot2c_f32_bf16 v11, v90, v22
v_dot2c_f32_bf16 v10, v79, v23
v_dot2c_f32_bf16 v11, v91, v23
v_dot2c_f32_bf16 v10, v80, v24
v_dot2c_f32_bf16 v11, v92, v24
v_dot2c_f32_bf16 v10, v81, v25
v_dot2c_f32_bf16 v11, v93, v25
v_dot2c_f32_bf16 v10, v82, v26
v_dot2c_f32_bf16 v11, v94, v26
v_dot2c_f32_bf16 v10, v83, v27
v_dot2c_f32_bf16 v11, v95, v27
s_waitcnt vmcnt(6)
v_dot2c_f32_bf16 v12, v96, v16
v_dot2c_f32_bf16 v13, v108, v16
v_dot2c_f32_bf16 v12, v97, v17
v_dot2c_f32_bf16 v13, v109, v17
v_dot2c_f32_bf16 v12, v98, v18
v_dot2c_f32_bf16 v13, v110, v18
v_dot2c_f32_bf16 v12, v99, v19
v_dot2c_f32_bf16 v13, v111, v19
v_dot2c_f32_bf16 v12, v100, v20
v_dot2c_f32_bf16 v13, v112, v20
v_dot2c_f32_bf16 v12, v101, v21
v_dot2c_f32_bf16 v13, v113, v21
v_dot2c_f32_bf16 v12, v102, v22
v_dot2c_f32_bf16 v13, v114, v22
v_dot2c_f32_bf16 v12, v103, v23
v_dot2c_f32_bf16 v13, v115, v23
v_dot2c_f32_bf16 v12, v104, v24
v_dot2c_f32_bf16 v13, v116, v24
v_dot2c_f32_bf16 v12, v105, v25
v_dot2c_f32_bf16 v13, v117, v25
v_dot2c_f32_bf16 v12, v106, v26
v_dot2c_f32_bf16 v13, v118, v26
v_dot2c_f32_bf16 v12, v107, v27
v_dot2c_f32_bf16 v13, v119, v27
s_waitcnt vmcnt(0)
v_dot2c_f32_bf16 v14, v120, v16
v_dot2c_f32_bf16 v15, v132, v16
v_dot2c_f32_bf16 v14, v121, v17
v_dot2c_f32_bf16 v15, v133, v17
v_dot2c_f32_bf16 v14, v122, v18
v_dot2c_f32_bf16 v15, v134, v18
v_dot2c_f32_bf16 v14, v123, v19
v_dot2c_f32_bf16 v15, v135, v19
v_dot2c_f32_bf16 v14, v124, v20
v_dot2c_f32_bf16 v15, v136, v20
v_dot2c_f32_bf16 v14, v125, v21
v_dot2c_f32_bf16 v15, v137, v21
v_dot2c_f32_bf16 v14, v126, v22
v_dot2c_f32_bf16 v15, v138, v22
v_dot2c_f32_bf16 v14, v127, v23
v_dot2c_f32_bf16 v15, v139, v23
v_dot2c_f32_bf16 v14, v128, v24
v_dot2c_f32_bf16 v15, v140, v24
v_dot2c_f32_bf16 v14, v129, v25
v_dot2c_f32_bf16 v15, v141, v25
v_dot2c_f32_bf16 v14, v130, v26
v_dot2c_f32_bf16 v15, v142, v26
v_dot2c_f32_bf16 v14, v131, v27
v_dot2c_f32_bf16 v15, v143, v27
v_add_f32_dpp v8, v8, v8 quad_perm:[1,0,3,2] row_mask:0xf bank_mask:0xf
v_add_f32_dpp v9, v9, v9 quad_perm:[1,0,3,2] row_mask:0xf bank_mask:0xf
v_add_f32_dpp v10, v10, v10 quad_perm:[1,0,3,2] row_mask:0xf bank_mask:0xf
v_add_f32_dpp v11, v11, v11 quad_perm:[1,0,3,2] row_mask:0xf bank_mask:0xf
v_add_f32_dpp v12, v12, v12 quad_perm:[1,0,3,2] row_mask:0xf bank_mask:0xf
v_add_f32_dpp v13, v13, v13 quad_perm:[1,0,3,2] row_mask:0xf bank_mask:0xf
v_add_f32_dpp v14, v14, v14 quad_perm:[1,0,3,2] row_mask:0xf bank_mask:0xf
v_add_f32_dpp v15, v15, v15 quad_perm:[1,0,3,2] row_mask:0xf bank_mask:0xf
v_add_f32_dpp v8, v8, v8 quad_perm:[2,3,0,1] row_mask:0xf bank_mask:0xf
v_add_f32_dpp v9, v9, v9 quad_perm:[2,3,0,1] row_mask:0xf bank_mask:0xf
v_add_f32_dpp v10, v10, v10 quad_perm:[2,3,0,1] row_mask:0xf bank_mask:0xf
v_add_f32_dpp v11, v11, v11 quad_perm:[2,3,0,1] row_mask:0xf bank_mask:0xf
v_add_f32_dpp v12, v12, v12 quad_perm:[2,3,0,1] row_mask:0xf bank_mask:0xf
v_add_f32_dpp v13, v13, v13 quad_perm:[2,3,0,1] row_mask:0xf bank_mask:0xf
v_add_f32_dpp v14, v14, v14 quad_perm:[2,3,0,1] row_mask:0xf bank_mask:0xf
v_add_f32_dpp v15, v15, v15 quad_perm:[2,3,0,1] row_mask:0xf bank_mask:0xf
v_add_f32_dpp v8, v8, v8 row_half_mirror row_mask:0xf bank_mask:0xf
v_add_f32_dpp v9, v9, v9 row_half_mirror row_mask:0xf bank_mask:0xf
v_add_f32_dpp v10, v10, v10 row_half_mirror row_mask:0xf bank_mask:0xf
v_add_f32_dpp v11, v11, v11 row_half_mirror row_mask:0xf bank_mask:0xf
v_add_f32_dpp v12, v12, v12 row_half_mirror row_mask:0xf bank_mask:0xf
v_add_f32_dpp v13, v13, v13 row_half_mirror row_mask:0xf bank_mask:0xf
v_add_f32_dpp v14, v14, v14 row_half_mirror row_mask:0xf bank_mask:0xf
v_add_f32_dpp v15, v15, v15 row_half_mirror row_mask:0xf bank_mask:0xf
v_cvt_pk_bf16_f32 v28, v8, v9
v_cvt_pk_bf16_f32 v29, v10, v11
v_cvt_pk_bf16_f32 v30, v12, v13
v_cvt_pk_bf16_f32 v31, v14, v15
v_lshlrev_b32 v8, 16, v28
v_and_b32 v9, 0xffff0000, v28
v_lshlrev_b32 v10, 16, v29
v_and_b32 v11, 0xffff0000, v29
v_lshlrev_b32 v12, 16, v30
v_and_b32 v13, 0xffff0000, v30
v_lshlrev_b32 v14, 16, v31
v_and_b32 v15, 0xffff0000, v31
v_mul_f32 v8, 0x3d93cd3a, v8
v_mul_f32 v9, 0x3d93cd3a, v9
v_mul_f32 v10, 0x3d93cd3a, v10
v_mul_f32 v11, 0x3d93cd3a, v11
v_mul_f32 v12, 0x3d93cd3a, v12
v_mul_f32 v13, 0x3d93cd3a, v13
v_mul_f32 v14, 0x3d93cd3a, v14
v_mul_f32 v15, 0x3d93cd3a, v15
v_cvt_pk_bf16_f32 v28, v8, v9
v_cvt_pk_bf16_f32 v29, v10, v11
v_cvt_pk_bf16_f32 v30, v12, v13
v_cvt_pk_bf16_f32 v31, v14, v15
v_lshlrev_b32 v8, 16, v28
v_and_b32 v9, 0xffff0000, v28
v_lshlrev_b32 v10, 16, v29
v_and_b32 v11, 0xffff0000, v29
v_lshlrev_b32 v12, 16, v30
v_and_b32 v13, 0xffff0000, v30
v_lshlrev_b32 v14, 16, v31
v_and_b32 v15, 0xffff0000, v31
v_max3_f32 v40, v8, v9, v10
v_max3_f32 v41, v11, v12, v13
v_max3_f32 v40, v40, v14, v15
v_max_f32 v40, v40, v41
s_nop 1
v_max_f32_dpp v40, v40, v40 row_ror:8 row_mask:0xf bank_mask:0xf
v_mov_b32 v41, v40
s_nop 1
v_permlane16_swap_b32 v40, v41
v_max_f32 v40, v40, v41
v_mov_b32 v41, v40
s_nop 1
v_permlane32_swap_b32 v40, v41
v_max_f32 v40, v40, v41
v_sub_f32 v28, v8, v40
v_sub_f32 v29, v9, v40
v_sub_f32 v30, v10, v40
v_sub_f32 v31, v11, v40
v_sub_f32 v32, v12, v40
v_sub_f32 v33, v13, v40
v_sub_f32 v34, v14, v40
v_sub_f32 v35, v15, v40
v_mul_f32 v28, 0x3fb8aa3b, v28
v_mul_f32 v29, 0x3fb8aa3b, v29
v_mul_f32 v30, 0x3fb8aa3b, v30
v_mul_f32 v31, 0x3fb8aa3b, v31
v_mul_f32 v32, 0x3fb8aa3b, v32
v_mul_f32 v33, 0x3fb8aa3b, v33
v_mul_f32 v34, 0x3fb8aa3b, v34
v_mul_f32 v35, 0x3fb8aa3b, v35
v_exp_f32 v28, v28
v_exp_f32 v29, v29
v_exp_f32 v30, v30
v_exp_f32 v31, v31
v_exp_f32 v32, v32
v_exp_f32 v33, v33
v_exp_f32 v34, v34
v_exp_f32 v35, v35
v_add_f32 v28, v28, v32
v_add_f32 v29, v29, v33
v_add_f32 v30, v30, v34
v_add_f32 v31, v31, v35
v_add_f32 v28, v28, v29
v_add_f32 v30, v30, v31
v_add_f32 v41, v28, v30
s_nop 1
v_add_f32_dpp v41, v41, v41 row_ror:8 row_mask:0xf bank_mask:0xf
v_mov_b32 v42, v41
s_nop 1
v_permlane16_swap_b32 v41, v42
v_add_f32 v41, v41, v42
v_mov_b32 v42, v41
s_nop 1
v_permlane32_swap_b32 v41, v42
v_add_f32 v41, v41, v42
s_lshl_b32 s51, s28, 3
v_mov_b32 v3, s51
v_mov_b32 v38, 1
s_mov_b64 exec, 1
ds_write_b64 v3, v[40:41] offset:32
ds_add_u32 v36, v38 offset:28
s_mov_b64 exec, -1
s_setprio 1
buffer_load_dwordx4 v[48:51], v2, s[40:43], s56 offen nt
s_addk_i32 s56, 128
buffer_load_dwordx4 v[52:55], v2, s[40:43], s56 offen nt
s_addk_i32 s56, 128
buffer_load_dwordx4 v[56:59], v2, s[40:43], s56 offen nt
s_mov_b32 s56, s57
buffer_load_dwordx4 v[60:63], v2, s[40:43], s56 offen nt
s_addk_i32 s56, 128
buffer_load_dwordx4 v[64:67], v2, s[40:43], s56 offen nt
s_addk_i32 s56, 128
buffer_load_dwordx4 v[68:71], v2, s[40:43], s56 offen nt
s_mov_b32 s56, s58
buffer_load_dwordx4 v[72:75], v2, s[40:43], s56 offen nt
s_addk_i32 s56, 128
buffer_load_dwordx4 v[76:79], v2, s[40:43], s56 offen nt
s_addk_i32 s56, 128
buffer_load_dwordx4 v[80:83], v2, s[40:43], s56 offen nt
s_mov_b32 s56, s59
buffer_load_dwordx4 v[84:87], v2, s[40:43], s56 offen nt
s_addk_i32 s56, 128
buffer_load_dwordx4 v[88:91], v2, s[40:43], s56 offen nt
s_addk_i32 s56, 128
buffer_load_dwordx4 v[92:95], v2, s[40:43], s56 offen nt
s_mov_b32 s56, s60
buffer_load_dwordx4 v[96:99], v2, s[40:43], s56 offen nt
s_addk_i32 s56, 128
buffer_load_dwordx4 v[100:103], v2, s[40:43], s56 offen nt
s_addk_i32 s56, 128
buffer_load_dwordx4 v[104:107], v2, s[40:43], s56 offen nt
s_mov_b32 s56, s61
buffer_load_dwordx4 v[108:111], v2, s[40:43], s56 offen nt
s_addk_i32 s56, 128
buffer_load_dwordx4 v[112:115], v2, s[40:43], s56 offen nt
s_addk_i32 s56, 128
buffer_load_dwordx4 v[116:119], v2, s[40:43], s56 offen nt
s_mov_b32 s56, s62
buffer_load_dwordx4 v[120:123], v2, s[40:43], s56 offen nt
s_addk_i32 s56, 128
buffer_load_dwordx4 v[124:127], v2, s[40:43], s56 offen nt
s_addk_i32 s56, 128
buffer_load_dwordx4 v[128:131], v2, s[40:43], s56 offen nt
s_mov_b32 s56, s63
buffer_load_dwordx4 v[132:135], v2, s[40:43], s56 offen nt
s_addk_i32 s56, 128
buffer_load_dwordx4 v[136:139], v2, s[40:43], s56 offen nt
s_addk_i32 s56, 128
buffer_load_dwordx4 v[140:143], v2, s[40:43], s56 offen nt
s_mov_b64 exec, 1
ds_add_u32 v36, v38 offset:32
s_mov_b64 exec, -1
s_setprio 3
v_bfe_u32 v39, v1, 4, 1
v_lshlrev_b32 v39, 4, v39
v_lshl_add_u32 v39, v46, 5, v39
v_lshrrev_b32 v3, 5, v1
v_lshl_add_u32 v39, v3, 3, v39
s_mul_i32 s51, s28, 768
v_add_u32 v39, s51, v39
v_mul_u32_u24 v0, 3072, v3
v_and_b32 v37, 31, v1
v_lshl_add_u32 v0, v37, 3, v0
v_lshlrev_b32 v3, 12, v3
v_lshl_add_u32 v3, v37, 4, v3
v_lshlrev_b32 v37, 3, v1
s_mul_i32 s51, s30, 12288
s_lshl_b32 s52, s31, 9
s_add_u32 s51, s51, s52
s_add_u32 s51, s51, 65536
s_add_u32 s52, s51, 8192
s_mov_b32 s50, 8388608
L_ms:
ds_read_b32 v38, v36 offset:8
ds_read_b96 v[40:42], v36 offset:16
s_waitcnt lgkmcnt(0)
v_cmp_ne_u32 vcc, 1, v38
s_cbranch_vccz L_ms_ok
s_sleep 1
s_sub_u32 s50, s50, 1
s_cbranch_scc0 L_ms
L_ms_ok:
v_readfirstlane_b32 s89, v42
v_sub_f32 v8, v8, v40
v_sub_f32 v9, v9, v40
v_sub_f32 v10, v10, v40
v_sub_f32 v11, v11, v40
v_sub_f32 v12, v12, v40
v_sub_f32 v13, v13, v40
v_sub_f32 v14, v14, v40
v_sub_f32 v15, v15, v40
v_mul_f32 v8, 0x3fb8aa3b, v8
v_mul_f32 v9, 0x3fb8aa3b, v9
v_mul_f32 v10, 0x3fb8aa3b, v10
v_mul_f32 v11, 0x3fb8aa3b, v11
v_mul_f32 v12, 0x3fb8aa3b, v12
v_mul_f32 v13, 0x3fb8aa3b, v13
v_mul_f32 v14, 0x3fb8aa3b, v14
v_mul_f32 v15, 0x3fb8aa3b, v15
v_exp_f32 v8, v8
v_exp_f32 v9, v9
v_exp_f32 v10, v10
v_exp_f32 v11, v11
v_exp_f32 v12, v12
v_exp_f32 v13, v13
v_exp_f32 v14, v14
v_exp_f32 v15, v15
v_mul_f32 v8, v8, v41
v_mul_f32 v9, v9, v41
v_mul_f32 v10, v10, v41
v_mul_f32 v11, v11, v41
v_mul_f32 v12, v12, v41
v_mul_f32 v13, v13, v41
v_mul_f32 v14, v14, v41
v_mul_f32 v15, v15, v41
v_cvt_pk_bf16_f32 v8, v8, v8
v_cvt_pk_bf16_f32 v9, v9, v9
v_cvt_pk_bf16_f32 v10, v10, v10
v_cvt_pk_bf16_f32 v11, v11, v11
v_cvt_pk_bf16_f32 v12, v12, v12
v_cvt_pk_bf16_f32 v13, v13, v13
v_cvt_pk_bf16_f32 v14, v14, v14
v_cvt_pk_bf16_f32 v15, v15, v15
s_add_u32 s67, s29, 16
v_mov_b32 v41, s67
v_mov_b32 v43, s67
v_mov_b32 v45, s67
v_mov_b32 v47, s67
v_and_b32 v28, v8, v4
v_and_b32 v29, v8, v5
v_and_b32 v30, v8, v6
v_and_b32 v31, v8, v7
s_waitcnt vmcnt(23)
s_nop 0
v_mfma_f32_16x16x32_bf16 v[16:19], v[28:31], v[48:51], 0
s_waitcnt vmcnt(22)
v_mfma_f32_16x16x32_bf16 v[20:23], v[28:31], v[52:55], 0
s_waitcnt vmcnt(21)
v_mfma_f32_16x16x32_bf16 v[24:27], v[28:31], v[56:59], 0
v_and_b32 v32, v9, v4
v_and_b32 v33, v9, v5
v_and_b32 v34, v9, v6
v_and_b32 v35, v9, v7
s_waitcnt vmcnt(20)
s_nop 0
v_mfma_f32_16x16x32_bf16 v[16:19], v[32:35], v[60:63], v[16:19]
s_waitcnt vmcnt(19)
v_mfma_f32_16x16x32_bf16 v[20:23], v[32:35], v[64:67], v[20:23]
s_waitcnt vmcnt(18)
v_mfma_f32_16x16x32_bf16 v[24:27], v[32:35], v[68:71], v[24:27]
v_and_b32 v28, v10, v4
v_and_b32 v29, v10, v5
v_and_b32 v30, v10, v6
v_and_b32 v31, v10, v7
s_waitcnt vmcnt(17)
s_nop 0
v_mfma_f32_16x16x32_bf16 v[16:19], v[28:31], v[72:75], v[16:19]
s_waitcnt vmcnt(16)
v_mfma_f32_16x16x32_bf16 v[20:23], v[28:31], v[76:79], v[20:23]
s_waitcnt vmcnt(15)
v_mfma_f32_16x16x32_bf16 v[24:27], v[28:31], v[80:83], v[24:27]
v_and_b32 v32, v11, v4
v_and_b32 v33, v11, v5
v_and_b32 v34, v11, v6
v_and_b32 v35, v11, v7
s_waitcnt vmcnt(14)
s_nop 0
v_mfma_f32_16x16x32_bf16 v[16:19], v[32:35], v[84:87], v[16:19]
s_waitcnt vmcnt(13)
v_mfma_f32_16x16x32_bf16 v[20:23], v[32:35], v[88:91], v[20:23]
s_waitcnt vmcnt(12)
v_mfma_f32_16x16x32_bf16 v[24:27], v[32:35], v[92:95], v[24:27]
v_and_b32 v28, v12, v4
v_and_b32 v29, v12, v5
v_and_b32 v30, v12, v6
v_and_b32 v31, v12, v7
s_waitcnt vmcnt(11)
s_nop 0
v_mfma_f32_16x16x32_bf16 v[16:19], v[28:31], v[96:99], v[16:19]
s_waitcnt vmcnt(10)
v_mfma_f32_16x16x32_bf16 v[20:23], v[28:31], v[100:103], v[20:23]
s_waitcnt vmcnt(9)
v_mfma_f32_16x16x32_bf16 v[24:27], v[28:31], v[104:107], v[24:27]
v_and_b32 v32, v13, v4
v_and_b32 v33, v13, v5
v_and_b32 v34, v13, v6
v_and_b32 v35, v13, v7
s_waitcnt vmcnt(8)
s_nop 0
v_mfma_f32_16x16x32_bf16 v[16:19], v[32:35], v[108:111], v[16:19]
s_waitcnt vmcnt(7)
v_mfma_f32_16x16x32_bf16 v[20:23], v[32:35], v[112:115], v[20:23]
s_waitcnt vmcnt(6)
v_mfma_f32_16x16x32_bf16 v[24:27], v[32:35], v[116:119], v[24:27]
v_and_b32 v28, v14, v4
v_and_b32 v29, v14, v5
v_and_b32 v30, v14, v6
v_and_b32 v31, v14, v7
s_waitcnt vmcnt(5)
s_nop 0
v_mfma_f32_16x16x32_bf16 v[16:19], v[28:31], v[120:123], v[16:19]
s_waitcnt vmcnt(4)
v_mfma_f32_16x16x32_bf16 v[20:23], v[28:31], v[124:127], v[20:23]
s_waitcnt vmcnt(3)
v_mfma_f32_16x16x32_bf16 v[24:27], v[28:31], v[128:131], v[24:27]
v_and_b32 v32, v15, v4
v_and_b32 v33, v15, v5
v_and_b32 v34, v15, v6
v_and_b32 v35, v15, v7
s_waitcnt vmcnt(2)
s_nop 0
v_mfma_f32_16x16x32_bf16 v[16:19], v[32:35], v[132:135], v[16:19]
s_waitcnt vmcnt(1)
v_mfma_f32_16x16x32_bf16 v[20:23], v[32:35], v[136:139], v[20:23]
s_nop 5
v_permlane32_swap_b32 v16, v18
v_permlane32_swap_b32 v17, v19
s_nop 0
v_add_f32_dpp v16, v18, v16 row_ror:8 row_mask:0xf bank_mask:0xf
v_add_f32_dpp v17, v19, v17 row_ror:8 row_mask:0xf bank_mask:0xf
s_mov_b64 exec, s[14:15]
ds_write_b64 v39, v[16:17] offset:512
s_mov_b64 exec, -1
s_waitcnt vmcnt(0)
v_mfma_f32_16x16x32_bf16 v[24:27], v[32:35], v[140:143], v[24:27]
v_permlane32_swap_b32 v20, v22
v_permlane32_swap_b32 v21, v23
s_nop 0
v_add_f32_dpp v20, v22, v20 row_ror:8 row_mask:0xf bank_mask:0xf
v_add_f32_dpp v21, v23, v21 row_ror:8 row_mask:0xf bank_mask:0xf
s_mov_b64 exec, s[14:15]
ds_write_b64 v39, v[20:21] offset:768
s_mov_b64 exec, -1
v_permlane32_swap_b32 v24, v26
v_permlane32_swap_b32 v25, v27
s_nop 0
v_add_f32_dpp v24, v26, v24 row_ror:8 row_mask:0xf bank_mask:0xf
v_add_f32_dpp v25, v27, v25 row_ror:8 row_mask:0xf bank_mask:0xf
s_mov_b64 exec, s[14:15]
ds_write_b64 v39, v[24:25] offset:1024
s_mov_b64 exec, 1
ds_add_rtn_u32 v38, v36, v38 offset:4
s_mov_b64 exec, -1
ds_read_b64 v[48:49], v37 offset:3584
ds_read_b64 v[50:51], v37 offset:4352
ds_read_b64 v[52:53], v37 offset:5120
ds_read_b64 v[54:55], v37 offset:5888
ds_read_b64 v[56:57], v37 offset:6656
ds_read_b64 v[58:59], v37 offset:7424
ds_read_b64 v[60:61], v37 offset:8192
ds_read_b64 v[62:63], v37 offset:8960
ds_read_b64 v[64:65], v0 offset:4096
ds_read_b64 v[66:67], v0 offset:4864
ds_read_b64 v[68:69], v0 offset:5632
ds_read_b64 v[70:71], v0 offset:6400
s_waitcnt lgkmcnt(4)
v_readfirstlane_b32 s53, v38
v_pk_add_f32 v[48:49], v[48:49], v[50:51]
v_pk_add_f32 v[52:53], v[52:53], v[54:55]
v_pk_add_f32 v[56:57], v[56:57], v[58:59]
v_pk_add_f32 v[60:61], v[60:61], v[62:63]
v_pk_add_f32 v[48:49], v[48:49], v[52:53]
v_pk_add_f32 v[56:57], v[56:57], v[60:61]
s_cmp_lg_u32 s53, 7
s_cbranch_scc1 L_main_end
v_add_f32 v40, v48, v56
v_add_f32 v42, v49, v57
s_cmp_lg_u32 s89, 1
s_cbranch_scc1 L_e4far
buffer_store_dwordx4 v[40:43], v3, s[32:35], s51 offen
s_waitcnt lgkmcnt(0)
v_pk_add_f32 v[64:65], v[64:65], v[66:67]
v_pk_add_f32 v[68:69], v[68:69], v[70:71]
v_pk_add_f32 v[64:65], v[64:65], v[68:69]
s_nop 1
v_permlane32_swap_b32 v64, v66
v_permlane32_swap_b32 v65, v67
v_add_f32 v44, v64, v66
v_add_f32 v46, v65, v67
s_mov_b32 exec_hi, 0
buffer_store_dwordx4 v[44:47], v3, s[32:35], s52 offen
L_e4done:
s_mov_b64 exec, 1
ds_write_b32 v36, v38 offset:40
L_main_end:
s_endpgm
L_e4far:
buffer_store_dwordx4 v[40:43], v3, s[32:35], s51 offen sc1
s_waitcnt lgkmcnt(0)
v_pk_add_f32 v[64:65], v[64:65], v[66:67]
v_pk_add_f32 v[68:69], v[68:69], v[70:71]
v_pk_add_f32 v[64:65], v[64:65], v[68:69]
s_nop 1
v_permlane32_swap_b32 v64, v66
v_permlane32_swap_b32 v65, v67
v_add_f32 v44, v64, v66
v_add_f32 v46, v65, v67
s_mov_b32 exec_hi, 0
buffer_store_dwordx4 v[44:47], v3, s[32:35], s52 offen sc1
s_branch L_e4done
L_ln:
s_waitcnt vmcnt(0)
ds_write_b128 v8, v[20:23] offset:9728
ds_write_b32 v3, v24 offset:10752
v_lshlrev_b32 v48, 16, v20
v_and_b32 v49, 0xffff0000, v20
v_lshlrev_b32 v50, 16, v21
v_and_b32 v51, 0xffff0000, v21
v_lshlrev_b32 v52, 16, v22
v_and_b32 v53, 0xffff0000, v22
v_lshlrev_b32 v54, 16, v23
v_and_b32 v55, 0xffff0000, v23
v_lshlrev_b32 v56, 16, v24
v_and_b32 v57, 0xffff0000, v24
v_pk_add_f32 v[40:41], v[48:49], v[50:51]
v_pk_add_f32 v[40:41], v[40:41], v[52:53]
v_pk_add_f32 v[40:41], v[40:41], v[54:55]
v_pk_add_f32 v[40:41], v[40:41], v[56:57]
v_add_f32 v40, v40, v41
s_nop 1
v_add_f32_dpp v40, v40, v40 quad_perm:[1,0,3,2] row_mask:0xf bank_mask:0xf
s_nop 1
v_add_f32_dpp v40, v40, v40 quad_perm:[2,3,0,1] row_mask:0xf bank_mask:0xf
s_nop 1
v_add_f32_dpp v40, v40, v40 row_ror:8 row_mask:0xf bank_mask:0xf
s_nop 1
v_add_f32_dpp v40, v40, v40 row_ror:4 row_mask:0xf bank_mask:0xf
v_mov_b32 v41, v40
s_nop 1
v_permlane16_swap_b32 v40, v41
v_add_f32 v40, v40, v41
v_mov_b32 v41, v40
s_nop 1
v_permlane32_swap_b32 v40, v41
v_add_f32 v40, v40, v41
v_mul_f32 v40, 0x3acccccd, v40
v_sub_f32 v60, v48, v40
v_sub_f32 v61, v49, v40
v_sub_f32 v62, v50, v40
v_sub_f32 v63, v51, v40
v_sub_f32 v64, v52, v40
v_sub_f32 v65, v53, v40
v_sub_f32 v66, v54, v40
v_sub_f32 v67, v55, v40
v_sub_f32 v68, v56, v40
v_sub_f32 v69, v57, v40
v_mul_f32 v42, v60, v60
v_mul_f32 v43, v61, v61
v_fmac_f32 v42, v62, v62
v_fmac_f32 v43, v63, v63
v_fmac_f32 v42, v64, v64
v_fmac_f32 v43, v65, v65
v_fmac_f32 v42, v66, v66
v_fmac_f32 v43, v67, v67
v_fmac_f32 v42, v68, v68
v_fmac_f32 v43, v69, v69
v_add_f32 v42, v42, v43
s_nop 1
v_add_f32_dpp v42, v42, v42 quad_perm:[1,0,3,2] row_mask:0xf bank_mask:0xf
s_nop 1
v_add_f32_dpp v42, v42, v42 quad_perm:[2,3,0,1] row_mask:0xf bank_mask:0xf
s_nop 1
v_add_f32_dpp v42, v42, v42 row_ror:8 row_mask:0xf bank_mask:0xf
s_nop 1
v_add_f32_dpp v42, v42, v42 row_ror:4 row_mask:0xf bank_mask:0xf
v_mov_b32 v41, v42
s_nop 1
v_permlane16_swap_b32 v42, v41
v_add_f32 v42, v42, v41
v_mov_b32 v41, v42
s_nop 1
v_permlane32_swap_b32 v42, v41
v_add_f32 v42, v42, v41
v_mul_f32 v42, 0x3acccccd, v42
v_cvt_pk_bf16_f32 v41, v40, v42
v_lshlrev_b32 v40, 16, v41
v_and_b32 v42, 0xffff0000, v41
v_add_f32 v42, 0x3727c5ac, v42
v_cvt_pk_bf16_f32 v42, v42, v42
v_lshlrev_b32 v42, 16, v42
v_sqrt_f32 v42, v42
v_sub_f32 v48, v48, v40
v_sub_f32 v49, v49, v40
v_sub_f32 v50, v50, v40
v_sub_f32 v51, v51, v40
v_sub_f32 v52, v52, v40
v_sub_f32 v53, v53, v40
v_sub_f32 v54, v54, v40
v_sub_f32 v55, v55, v40
v_sub_f32 v56, v56, v40
v_sub_f32 v57, v57, v40
v_cvt_pk_bf16_f32 v42, v42, v42
v_lshlrev_b32 v42, 16, v42
v_rcp_f32 v42, v42
v_cvt_pk_bf16_f32 v20, v48, v49
v_cvt_pk_bf16_f32 v21, v50, v51
v_cvt_pk_bf16_f32 v22, v52, v53
v_cvt_pk_bf16_f32 v23, v54, v55
v_cvt_pk_bf16_f32 v24, v56, v57
v_lshlrev_b32 v48, 16, v20
v_and_b32 v49, 0xffff0000, v20
v_lshlrev_b32 v50, 16, v21
v_and_b32 v51, 0xffff0000, v21
v_lshlrev_b32 v52, 16, v22
v_and_b32 v53, 0xffff0000, v22
v_lshlrev_b32 v54, 16, v23
v_and_b32 v55, 0xffff0000, v23
v_lshlrev_b32 v56, 16, v24
v_and_b32 v57, 0xffff0000, v24
v_mul_f32 v48, v48, v42
v_mul_f32 v49, v49, v42
v_mul_f32 v50, v50, v42
v_mul_f32 v51, v51, v42
v_mul_f32 v52, v52, v42
v_mul_f32 v53, v53, v42
v_mul_f32 v54, v54, v42
v_mul_f32 v55, v55, v42
v_mul_f32 v56, v56, v42
v_mul_f32 v57, v57, v42
v_cvt_pk_bf16_f32 v20, v48, v49
v_cvt_pk_bf16_f32 v21, v50, v51
v_cvt_pk_bf16_f32 v22, v52, v53
v_cvt_pk_bf16_f32 v23, v54, v55
v_cvt_pk_bf16_f32 v24, v56, v57
v_mov_b32 v38, 1
ds_write_b128 v8, v[20:23] offset:2304
ds_write_b32 v3, v24 offset:3328
s_mov_b64 exec, 1
ds_write_b32 v36, v38 offset:12
s_mov_b64 exec, -1
s_branch L_lnback
L_h012b:
s_lshr_b32 s49, s2, 3
s_mul_i32 s66, s49, 26
s_lshr_b32 s66, s66, 8
s_mul_i32 s51, s66, 10
s_sub_u32 s49, s49, s51
s_and_b32 s51, s2, 7
s_mul_i32 s51, s51, 3
s_add_u32 s48, s51, s66
v_and_b32 v3, 1, v1
v_lshlrev_b32 v3, 4, v3
v_mov_b32 v7, 0xffff
v_lshlrev_b32 v3, v3, v7
v_bfe_u32 v7, v1, 1, 2
v_cmp_eq_u32 vcc, 0, v7
v_cmp_eq_u32 s[92:93], 1, v7
v_cmp_eq_u32 s[94:95], 2, v7
v_cndmask_b32 v4, 0, v3, vcc
v_cmp_eq_u32 vcc, 3, v7
v_cndmask_b32 v5, 0, v3, s[92:93]
v_cndmask_b32 v6, 0, v3, s[94:95]
v_cndmask_b32 v7, 0, v3, vcc
s_mov_b32 s14, 0x00ff00ff
s_mov_b32 s15, s14
v_lshrrev_b32 v18, 4, v1
v_lshlrev_b32 v18, 7, v18
v_lshl_add_u32 v18, v46, 4, v18
v_bfe_u32 v0, v1, 3, 1
v_lshlrev_b32 v0, 5, v0
v_bfe_u32 v3, v1, 4, 1
v_lshl_add_u32 v0, v3, 2, v0
v_lshrrev_b32 v3, 5, v1
v_lshl_add_u32 v0, v3, 1, v0
v_lshrrev_b32 v19, 2, v46
v_lshlrev_b32 v19, 9, v19
v_lshl_add_u32 v19, v45, 6, v19
v_and_b32 v3, 3, v1
v_lshl_add_u32 v19, v3, 4, v19
v_mov_b32 v44, 0
s_mov_b64 s[32:33], s[26:27]
s_mov_b32 s34, 704512
s_mov_b32 s35, 0x20000
s_mul_i32 s51, s31, 160
s_add_u32 s51, s51, 2304
v_mul_u32_u24 v3, 2, v45
v_add_u32 v3, s51, v3
s_mov_b32 s50, 8388608
L_gx10:
ds_read_b32 v47, v44 offset:12
ds_read_u16 v8, v3 offset:0
ds_read_u16 v9, v3 offset:16
ds_read_u16 v10, v3 offset:32
ds_read_u16 v11, v3 offset:48
ds_read_u16 v12, v3 offset:64
ds_read_u16 v13, v3 offset:80
ds_read_u16 v14, v3 offset:96
ds_read_u16 v15, v3 offset:112
ds_read_u16 v16, v3 offset:128
ds_read_u16 v17, v3 offset:144
s_waitcnt lgkmcnt(0)
v_cmp_ne_u32 vcc, 1, v47
s_cbranch_vccz L_gx10_ok
s_sleep 1
s_sub_u32 s50, s50, 1
s_cbranch_scc0 L_gx10
L_gx10_ok:
v_lshl_or_b32 v8, v8, 16, v8
v_lshl_or_b32 v9, v9, 16, v9
v_lshl_or_b32 v10, v10, 16, v10
v_lshl_or_b32 v11, v11, 16, v11
v_lshl_or_b32 v12, v12, 16, v12
v_lshl_or_b32 v13, v13, 16, v13
v_lshl_or_b32 v14, v14, 16, v14
v_lshl_or_b32 v15, v15, 16, v15
v_lshl_or_b32 v16, v16, 16, v16
v_lshl_or_b32 v17, v17, 16, v17
s_mul_i32 s67, s3, 0x9e3779b1
s_lshr_b32 s67, s67, 2
s_bitset1_b32 s67, 30
s_add_u32 s29, s29, s67
s_and_b32 s29, s29, -16
s_getreg_b32 s67, hwreg(HW_REG_XCC_ID, 0, 4)
s_or_b32 s67, s67, s29
v_and_b32 v20, v8, v4
v_and_b32 v21, v8, v5
v_and_b32 v22, v8, v6
v_and_b32 v23, v8, v7
s_waitcnt vmcnt(9)
s_nop 0
v_mfma_f32_16x16x32_bf16 v[28:31], v[20:23], v[48:51], 0
v_and_b32 v24, v9, v4
v_and_b32 v25, v9, v5
v_and_b32 v26, v9, v6
v_and_b32 v27, v9, v7
s_waitcnt vmcnt(8)
s_nop 0
v_mfma_f32_16x16x32_bf16 v[28:31], v[24:27], v[52:55], v[28:31]
v_and_b32 v20, v10, v4
v_and_b32 v21, v10, v5
v_and_b32 v22, v10, v6
v_and_b32 v23, v10, v7
s_waitcnt vmcnt(7)
s_nop 0
v_mfma_f32_16x16x32_bf16 v[28:31], v[20:23], v[56:59], v[28:31]
v_and_b32 v24, v11, v4
v_and_b32 v25, v11, v5
v_and_b32 v26, v11, v6
v_and_b32 v27, v11, v7
s_waitcnt vmcnt(6)
s_nop 0
v_mfma_f32_16x16x32_bf16 v[28:31], v[24:27], v[60:63], v[28:31]
v_and_b32 v20, v12, v4
v_and_b32 v21, v12, v5
v_and_b32 v22, v12, v6
v_and_b32 v23, v12, v7
s_waitcnt vmcnt(5)
s_nop 0
v_mfma_f32_16x16x32_bf16 v[28:31], v[20:23], v[64:67], v[28:31]
v_and_b32 v24, v13, v4
v_and_b32 v25, v13, v5
v_and_b32 v26, v13, v6
v_and_b32 v27, v13, v7
s_waitcnt vmcnt(4)
s_nop 0
v_mfma_f32_16x16x32_bf16 v[28:31], v[24:27], v[68:71], v[28:31]
v_and_b32 v20, v14, v4
v_and_b32 v21, v14, v5
v_and_b32 v22, v14, v6
v_and_b32 v23, v14, v7
s_waitcnt vmcnt(3)
s_nop 0
v_mfma_f32_16x16x32_bf16 v[28:31], v[20:23], v[72:75], v[28:31]
v_and_b32 v24, v15, v4
v_and_b32 v25, v15, v5
v_and_b32 v26, v15, v6
v_and_b32 v27, v15, v7
s_waitcnt vmcnt(2)
s_nop 0
v_mfma_f32_16x16x32_bf16 v[28:31], v[24:27], v[76:79], v[28:31]
v_and_b32 v20, v16, v4
v_and_b32 v21, v16, v5
v_and_b32 v22, v16, v6
v_and_b32 v23, v16, v7
s_waitcnt vmcnt(1)
s_nop 0
v_mfma_f32_16x16x32_bf16 v[28:31], v[20:23], v[80:83], v[28:31]
v_and_b32 v24, v17, v4
v_and_b32 v25, v17, v5
v_and_b32 v26, v17, v6
v_and_b32 v27, v17, v7
s_waitcnt vmcnt(0)
s_nop 0
v_mfma_f32_16x16x32_bf16 v[28:31], v[24:27], v[84:87], v[28:31]
s_mul_i32 s51, s30, 3
s_add_u32 s51, s51, s28
s_lshl_b32 s51, s51, 12
s_add_u32 s51, s51, 65536
s_lshl_b32 s52, s31, 9
s_add_u32 s52, s52, s51
s_mov_b32 s88, 0
v_mov_b32 v33, s67
v_permlane32_swap_b32 v28, v30
v_permlane32_swap_b32 v29, v31
v_mov_b32 v35, s67
v_add_f32_dpp v32, v30, v28 row_ror:8 row_mask:0xf bank_mask:0xf
v_add_f32_dpp v34, v31, v29 row_ror:8 row_mask:0xf bank_mask:0xf
s_mov_b64 exec, s[14:15]
buffer_store_dwordx4 v[32:35], v18, s[32:35], s52 offen
s_mov_b64 exec, -1
s_waitcnt vmcnt(0)
s_mov_b32 s50, 24
buffer_load_dwordx4 v[96:99], v19, s[32:35], s51 offen offset:0 sc1
buffer_load_dwordx4 v[100:103], v19, s[32:35], s51 offen offset:1024 sc1
buffer_load_dwordx4 v[104:107], v19, s[32:35], s51 offen offset:2048 sc1
buffer_load_dwordx4 v[108:111], v19, s[32:35], s51 offen offset:3072 sc1
L_p1:
s_waitcnt vmcnt(0)
v_bitop3_b32 v112, s67, v97, v99 bitop3:0x7e
v_bitop3_b32 v113, s67, v101, v103 bitop3:0x7e
v_bitop3_b32 v114, s67, v105, v107 bitop3:0x7e
v_bitop3_b32 v115, s67, v109, v111 bitop3:0x7e
v_or3_b32 v116, v112, v113, v114
v_or_b32 v116, v115, v116
v_cmp_lt_u32 vcc, s88, v116
v_add_f32 v116, v96, v100
v_add_f32 v117, v98, v102
v_add_f32 v118, v104, v108
v_add_f32 v119, v106, v110
s_cbranch_vccz L_p1_ok
v_cmp_lt_u32 s[92:93], s88, v112
v_cmp_lt_u32 s[94:95], s88, v113
v_cmp_lt_u32 s[96:97], s88, v114
v_cmp_lt_u32 s[98:99], s88, v115
s_sleep 4
s_mov_b64 exec, s[92:93]
s_cbranch_execz L_p1_s0
buffer_load_dwordx4 v[96:99], v19, s[32:35], s51 offen offset:0 sc1
L_p1_s0:
s_mov_b64 exec, s[94:95]
s_cbranch_execz L_p1_s1
buffer_load_dwordx4 v[100:103], v19, s[32:35], s51 offen offset:1024 sc1
L_p1_s1:
s_mov_b64 exec, s[96:97]
s_cbranch_execz L_p1_s2
buffer_load_dwordx4 v[104:107], v19, s[32:35], s51 offen offset:2048 sc1
L_p1_s2:
s_mov_b64 exec, s[98:99]
s_cbranch_execz L_p1_s3
buffer_load_dwordx4 v[108:111], v19, s[32:35], s51 offen offset:3072 sc1
L_p1_s3:
s_mov_b64 exec, -1
s_sub_u32 s50, s50, 1
s_cbranch_scc0 L_p1
s_cmp_lg_u32 s88, 0
s_cbranch_scc1 L_p1_giveup
s_mov_b32 s88, 15
s_mov_b32 s50, 131072
s_mov_b64 exec, s[14:15]
buffer_store_dwordx4 v[32:35], v18, s[32:35], s52 offen sc1
s_mov_b64 exec, -1
s_branch L_p1
L_p1_giveup:
s_waitcnt vmcnt(0)
L_p1_ok:
v_pk_add_f32 v[116:117], v[116:117], v[118:119]
s_nop 1
v_add_f32_dpp v118, v116, v116 row_shl:4 row_mask:0xf bank_mask:0x5
v_add_f32_dpp v119, v117, v117 row_shl:4 row_mask:0xf bank_mask:0x5
v_add_f32_dpp v118, v116, v116 row_shr:4 row_mask:0xf bank_mask:0xa
v_add_f32_dpp v119, v117, v117 row_shr:4 row_mask:0xf bank_mask:0xa
v_cvt_pk_bf16_f32 v96, v118, v119
v_and_b32 v3, 3, v1
v_lshlrev_b32 v3, 4, v3
v_lshl_add_u32 v3, v0, 1, v3
s_lshl_b32 s51, s28, 7
v_add_u32 v3, s51, v3
ds_write_b32 v3, v96 offset:512
v_mov_b32 v38, 1
s_mov_b64 exec, 1
ds_add_u32 v44, v38 offset:0
s_mov_b64 exec, -1
s_cmp_lg_u32 s28, 2
s_cbranch_scc1 L_wo
v_lshlrev_b32 v3, 4, v1
s_lshl_b32 s51, s30, 10
s_add_u32 s51, s51, 4096
v_lshlrev_b32 v39, 3, v46
v_mov_b32 v41, s29
v_mov_b32 v43, s29
s_lshl_b32 s52, s31, 7
s_add_u32 s52, s52, s51
s_mov_b32 s50, 8388608
L_gl:
ds_read_b32 v37, v44 offset:24
s_waitcnt lgkmcnt(0)
v_cmp_eq_u32 vcc, 0, v37
s_cbranch_vccz L_gl_ok
s_sleep 1
s_sub_u32 s50, s50, 1
s_cbranch_scc0 L_gl
L_gl_ok:
v_readfirstlane_b32 s89, v37
s_mov_b32 s50, 8388608
L_gk:
ds_read_b32 v37, v44 offset:28
ds_read_b32 v40, v39 offset:64
ds_read_b32 v42, v39 offset:68
s_waitcnt lgkmcnt(0)
v_cmp_ne_u32 vcc, 8, v37
s_cbranch_vccz L_gk_ok
s_sleep 1
s_sub_u32 s50, s50, 1
s_cbranch_scc0 L_gk
L_gk_ok:
s_mov_b64 exec, 0xff
s_cmp_eq_u32 s89, 1
s_cbranch_scc1 L_fl0_p
buffer_store_dwordx4 v[40:43], v3, s[32:35], s52 offen sc1
s_branch L_fl0_e
L_fl0_p:
buffer_store_dwordx4 v[40:43], v3, s[32:35], s52 offen
L_fl0_e:
s_mov_b64 exec, -1
s_mov_b32 s50, 131072
L_p0:
buffer_load_dwordx4 v[96:99], v3, s[32:35], s51 offen sc1
s_waitcnt vmcnt(0)
v_bitop3_b32 v97, s29, v97, v99 bitop3:0x7e
v_cmp_ne_u32 vcc, 0, v97
s_cbranch_vccz L_p0_ok
s_sleep 8
s_sub_u32 s50, s50, 1
s_cbranch_scc0 L_p0
L_p0_ok:
v_mov_b32 v40, v96
s_nop 1
v_max_f32_dpp v40, v40, v40 quad_perm:[1,0,3,2] row_mask:0xf bank_mask:0xf
s_nop 1
v_max_f32_dpp v40, v40, v40 quad_perm:[2,3,0,1] row_mask:0xf bank_mask:0xf
s_nop 1
v_max_f32_dpp v40, v40, v40 row_ror:8 row_mask:0xf bank_mask:0xf
s_nop 1
v_max_f32_dpp v40, v40, v40 row_ror:4 row_mask:0xf bank_mask:0xf
v_mov_b32 v41, v40
s_nop 1
v_permlane16_swap_b32 v40, v41
v_max_f32 v40, v40, v41
v_mov_b32 v41, v40
s_nop 1
v_permlane32_swap_b32 v40, v41
v_max_f32 v40, v40, v41
v_sub_f32 v96, v96, v40
v_mul_f32 v96, 0x3fb8aa3b, v96
v_exp_f32 v96, v96
s_nop 0
v_mul_f32 v42, v96, v98
s_nop 1
v_add_f32_dpp v42, v42, v42 quad_perm:[1,0,3,2] row_mask:0xf bank_mask:0xf
s_nop 1
v_add_f32_dpp v42, v42, v42 quad_perm:[2,3,0,1] row_mask:0xf bank_mask:0xf
s_nop 1
v_add_f32_dpp v42, v42, v42 row_ror:8 row_mask:0xf bank_mask:0xf
s_nop 1
v_add_f32_dpp v42, v42, v42 row_ror:4 row_mask:0xf bank_mask:0xf
v_mov_b32 v41, v42
s_nop 1
v_permlane16_swap_b32 v42, v41
v_add_f32 v42, v42, v41
v_mov_b32 v41, v42
s_nop 1
v_permlane32_swap_b32 v42, v41
v_add_f32 v42, v42, v41
v_rcp_f32 v41, v42
s_mov_b64 exec, 1
ds_write_b64 v44, v[40:41] offset:16
ds_write_b32 v44, v38 offset:8
s_mov_b64 exec, -1
s_branch L_wo
L_h3i:
v_lshrrev_b32 v18, 4, v1
v_lshlrev_b32 v18, 7, v18
v_lshl_add_u32 v18, v46, 4, v18
v_bfe_u32 v0, v1, 3, 1
v_lshlrev_b32 v0, 5, v0
v_bfe_u32 v3, v1, 4, 1
v_lshl_add_u32 v0, v3, 2, v0
v_lshrrev_b32 v3, 5, v1
v_lshl_add_u32 v0, v3, 1, v0
v_lshrrev_b32 v19, 2, v46
v_lshlrev_b32 v19, 9, v19
v_lshl_add_u32 v19, v45, 6, v19
v_and_b32 v3, 3, v1
v_lshl_add_u32 v19, v3, 4, v19
v_mov_b32 v44, 0
s_mov_b64 s[32:33], s[26:27]
s_mov_b32 s34, 704512
s_mov_b32 s35, 0x20000
s_cmpk_ge_u32 s2, 250
s_cbranch_scc1 L_h3c
s_sub_u32 s51, s2, 240
s_lshl_b32 s52, s51, 7
s_add_u32 s52, s52, 61440
s_lshl_b32 s51, s51, 11
s_add_u32 s51, s51, 40960
v_mov_b32 v20, 0
v_mov_b32 v21, 0
v_mov_b32 v22, 0
v_mov_b32 v23, 0
v_lshlrev_b32 v3, 4, v1
buffer_store_dwordx4 v[20:23], v3, s[32:35], s51 offen sc1
buffer_store_dwordx4 v[20:23], v3, s[32:35], s51 offen offset:1024 sc1
s_waitcnt vmcnt(0) lgkmcnt(0)
s_mul_i32 s53, s3, 0x9e3779b1
s_lshr_b32 s53, s53, 2
s_bitset1_b32 s53, 30
s_add_u32 s51, s29, s53
s_and_b32 s51, s51, -16
v_mov_b32 v24, s51
v_mov_b32 v25, s51
v_mov_b32 v26, s51
v_mov_b32 v27, s51
s_mov_b64 exec, 0xff
buffer_store_dwordx4 v[24:27], v3, s[32:35], s52 offen sc1
s_mov_b64 exec, -1
s_branch L_h3c
L_h3b:
v_and_b32 v3, 1, v1
v_lshlrev_b32 v3, 4, v3
v_mov_b32 v7, 0xffff
v_lshlrev_b32 v3, v3, v7
v_bfe_u32 v7, v1, 1, 2
v_cmp_eq_u32 vcc, 0, v7
v_cmp_eq_u32 s[92:93], 1, v7
v_cmp_eq_u32 s[94:95], 2, v7
v_cndmask_b32 v4, 0, v3, vcc
v_cmp_eq_u32 vcc, 3, v7
v_cndmask_b32 v5, 0, v3, s[92:93]
v_cndmask_b32 v6, 0, v3, s[94:95]
v_cndmask_b32 v7, 0, v3, vcc
s_mov_b32 s14, 0x00ff00ff
s_mov_b32 s15, s14
v_lshrrev_b32 v18, 4, v1
v_lshlrev_b32 v18, 7, v18
v_lshl_add_u32 v18, v46, 4, v18
v_bfe_u32 v0, v1, 3, 1
v_lshlrev_b32 v0, 5, v0
v_bfe_u32 v3, v1, 4, 1
v_lshl_add_u32 v0, v3, 2, v0
v_lshrrev_b32 v3, 5, v1
v_lshl_add_u32 v0, v3, 1, v0
v_lshrrev_b32 v19, 2, v46
v_lshlrev_b32 v19, 9, v19
v_lshl_add_u32 v19, v45, 6, v19
v_and_b32 v3, 3, v1
v_lshl_add_u32 v19, v3, 4, v19
v_mov_b32 v44, 0
s_mov_b64 s[32:33], s[26:27]
s_mov_b32 s34, 704512
s_mov_b32 s35, 0x20000
s_lshl_b32 s51, s49, 7
s_add_u32 s51, s51, 2304
v_lshl_add_u32 v3, v45, 1, s51
s_mov_b32 s50, 8388608
L_gx8:
ds_read_b32 v47, v44 offset:12
ds_read_u16 v8, v3 offset:0
ds_read_u16 v9, v3 offset:16
ds_read_u16 v10, v3 offset:32
ds_read_u16 v11, v3 offset:48
ds_read_u16 v12, v3 offset:64
ds_read_u16 v13, v3 offset:80
ds_read_u16 v14, v3 offset:96
ds_read_u16 v15, v3 offset:112
s_waitcnt lgkmcnt(0)
v_cmp_ne_u32 vcc, 1, v47
s_cbranch_vccz L_gx8_ok
s_sleep 1
s_sub_u32 s50, s50, 1
s_cbranch_scc0 L_gx8
L_gx8_ok:
v_lshl_or_b32 v8, v8, 16, v8
v_lshl_or_b32 v9, v9, 16, v9
v_lshl_or_b32 v10, v10, 16, v10
v_lshl_or_b32 v11, v11, 16, v11
v_lshl_or_b32 v12, v12, 16, v12
v_lshl_or_b32 v13, v13, 16, v13
v_lshl_or_b32 v14, v14, 16, v14
v_lshl_or_b32 v15, v15, 16, v15
v_and_b32 v20, v8, v4
v_and_b32 v21, v8, v5
v_and_b32 v22, v8, v6
v_and_b32 v23, v8, v7
s_waitcnt vmcnt(14)
s_nop 0
v_mfma_f32_16x16x32_bf16 v[28:31], v[20:23], v[48:51], 0
v_mfma_f32_16x16x32_bf16 v[32:35], v[20:23], v[52:55], 0
v_and_b32 v24, v9, v4
v_and_b32 v25, v9, v5
v_and_b32 v26, v9, v6
v_and_b32 v27, v9, v7
s_waitcnt vmcnt(12)
s_nop 0
v_mfma_f32_16x16x32_bf16 v[28:31], v[24:27], v[56:59], v[28:31]
v_mfma_f32_16x16x32_bf16 v[32:35], v[24:27], v[60:63], v[32:35]
v_and_b32 v20, v10, v4
v_and_b32 v21, v10, v5
v_and_b32 v22, v10, v6
v_and_b32 v23, v10, v7
s_waitcnt vmcnt(10)
s_nop 0
v_mfma_f32_16x16x32_bf16 v[28:31], v[20:23], v[64:67], v[28:31]
v_mfma_f32_16x16x32_bf16 v[32:35], v[20:23], v[68:71], v[32:35]
v_and_b32 v24, v11, v4
v_and_b32 v25, v11, v5
v_and_b32 v26, v11, v6
v_and_b32 v27, v11, v7
s_waitcnt vmcnt(8)
s_nop 0
v_mfma_f32_16x16x32_bf16 v[28:31], v[24:27], v[72:75], v[28:31]
v_mfma_f32_16x16x32_bf16 v[32:35], v[24:27], v[76:79], v[32:35]
v_and_b32 v20, v12, v4
v_and_b32 v21, v12, v5
v_and_b32 v22, v12, v6
v_and_b32 v23, v12, v7
s_waitcnt vmcnt(6)
s_nop 0
v_mfma_f32_16x16x32_bf16 v[28:31], v[20:23], v[80:83], v[28:31]
v_mfma_f32_16x16x32_bf16 v[32:35], v[20:23], v[84:87], v[32:35]
v_and_b32 v24, v13, v4
v_and_b32 v25, v13, v5
v_and_b32 v26, v13, v6
v_and_b32 v27, v13, v7
s_waitcnt vmcnt(4)
s_nop 0
v_mfma_f32_16x16x32_bf16 v[28:31], v[24:27], v[88:91], v[28:31]
v_mfma_f32_16x16x32_bf16 v[32:35], v[24:27], v[92:95], v[32:35]
v_and_b32 v20, v14, v4
v_and_b32 v21, v14, v5
v_and_b32 v22, v14, v6
v_and_b32 v23, v14, v7
s_waitcnt vmcnt(2)
s_nop 0
v_mfma_f32_16x16x32_bf16 v[28:31], v[20:23], v[96:99], v[28:31]
v_mfma_f32_16x16x32_bf16 v[32:35], v[20:23], v[100:103], v[32:35]
v_and_b32 v24, v15, v4
v_and_b32 v25, v15, v5
v_and_b32 v26, v15, v6
v_and_b32 v27, v15, v7
s_waitcnt vmcnt(0)
s_nop 0
v_mfma_f32_16x16x32_bf16 v[28:31], v[24:27], v[104:107], v[28:31]
v_mfma_f32_16x16x32_bf16 v[32:35], v[24:27], v[108:111], v[32:35]
L_h3c:
v_and_b32 v3, 3, v1
v_mul_u32_u24 v3, 98304, v3
v_lshrrev_b32 v2, 2, v1
v_lshl_add_u32 v3, v2, 9, v3
s_and_b32 s51, s2, 7
s_mul_i32 s51, s51, 12288
s_add_u32 s51, s51, 65536
s_mov_b32 s50, 8388608
L_gq:
ds_read_b32 v47, v44 offset:0
s_waitcnt lgkmcnt(0)
v_cmp_ne_u32 vcc, 3, v47
s_cbranch_vccz L_gq_ok
s_sleep 1
s_sub_u32 s50, s50, 1
s_cbranch_scc0 L_gq
L_gq_ok:
s_mul_i32 s67, s3, 0x9e3779b1
s_lshr_b32 s67, s67, 2
s_bitset1_b32 s67, 30
s_add_u32 s29, s29, s67
s_and_b32 s29, s29, -16
s_getreg_b32 s67, hwreg(HW_REG_XCC_ID, 0, 4)
s_or_b32 s67, s67, s29
s_mov_b32 s89, 1
s_mov_b32 exec_hi, 0
s_mov_b32 s50, 6
L_pl:
buffer_load_dwordx4 v[96:99], v3, s[32:35], s51 offen sc1
s_waitcnt vmcnt(0)
v_bitop3_b32 v97, s67, v97, v99 bitop3:0x7e
v_cmp_ne_u32 vcc, 0, v97
s_cbranch_vccz L_pl_ok
s_sleep 8
s_sub_u32 s50, s50, 1
s_cbranch_scc0 L_pl
s_mov_b32 s89, 2
L_pl_ok:
v_mov_b32 v47, s89
s_mov_b64 exec, 1
ds_write_b32 v44, v47 offset:24
s_mov_b64 exec, -1
s_cmpk_ge_u32 s2, 240
s_cbranch_scc1 L_help_end
s_mul_i32 s56, s48, 10240
s_add_u32 s56, s56, 458752
s_add_u32 s57, s56, 4096
s_add_u32 s58, s56, 8192
s_lshl_b32 s51, s49, 10
s_add_u32 s51, s51, s56
v_permlane32_swap_b32 v28, v30
v_permlane32_swap_b32 v29, v31
v_mov_b32 v37, s29
v_mov_b32 v39, s29
v_add_f32_dpp v36, v30, v28 row_ror:8 row_mask:0xf bank_mask:0xf
v_add_f32_dpp v38, v31, v29 row_ror:8 row_mask:0xf bank_mask:0xf
v_permlane32_swap_b32 v32, v34
v_permlane32_swap_b32 v33, v35
v_mov_b32 v41, s29
v_mov_b32 v43, s29
v_add_f32_dpp v40, v34, v32 row_ror:8 row_mask:0xf bank_mask:0xf
v_add_f32_dpp v42, v35, v33 row_ror:8 row_mask:0xf bank_mask:0xf
s_mov_b64 exec, s[14:15]
s_cmp_eq_u32 s89, 1
s_cbranch_scc1 L_fl1_p
buffer_store_dwordx4 v[36:39], v18, s[32:35], s51 offen sc1
buffer_store_dwordx4 v[40:43], v18, s[32:35], s51 offen offset:512 sc1
s_branch L_fl1_e
L_fl1_p:
buffer_store_dwordx4 v[36:39], v18, s[32:35], s51 offen
buffer_store_dwordx4 v[40:43], v18, s[32:35], s51 offen offset:512
L_fl1_e:
s_mov_b64 exec, -1
s_mul_i32 s51, s48, 81920
s_lshl_b32 s52, s49, 7
s_add_u32 s51, s51, s52
s_mov_b64 s[40:41], s[20:21]
s_mov_b32 s42, 1966080
s_mov_b32 s43, 0x20000
v_mul_u32_u24 v2, 1280, v0
v_lshl_add_u32 v2, v46, 4, v2
s_mov_b32 s50, 8388608
L_gk3:
ds_read_b32 v47, v44 offset:28
s_waitcnt lgkmcnt(0)
v_cmp_ne_u32 vcc, 8, v47
s_cbranch_vccz L_gk3_ok
s_sleep 1
s_sub_u32 s50, s50, 1
s_cbranch_scc0 L_gk3
L_gk3_ok:
buffer_load_dwordx4 v[48:51], v2, s[40:43], s51 offen nt
s_addk_i32 s51, 1280
buffer_load_dwordx4 v[52:55], v2, s[40:43], s51 offen nt
s_addk_i32 s51, 8960
buffer_load_dwordx4 v[56:59], v2, s[40:43], s51 offen nt
s_addk_i32 s51, 1280
buffer_load_dwordx4 v[60:63], v2, s[40:43], s51 offen nt
s_addk_i32 s51, 8960
buffer_load_dwordx4 v[64:67], v2, s[40:43], s51 offen nt
s_addk_i32 s51, 1280
buffer_load_dwordx4 v[68:71], v2, s[40:43], s51 offen nt
s_addk_i32 s51, 8960
buffer_load_dwordx4 v[72:75], v2, s[40:43], s51 offen nt
s_addk_i32 s51, 1280
buffer_load_dwordx4 v[76:79], v2, s[40:43], s51 offen nt
s_mov_b32 s50, 131072
L_p2:
buffer_load_dwordx4 v[96:99], v19, s[32:35], s56 offen offset:0 sc1
buffer_load_dwordx4 v[100:103], v19, s[32:35], s56 offen offset:1024 sc1
buffer_load_dwordx4 v[104:107], v19, s[32:35], s56 offen offset:2048 sc1
buffer_load_dwordx4 v[108:111], v19, s[32:35], s56 offen offset:3072 sc1
buffer_load_dwordx4 v[112:115], v19, s[32:35], s57 offen offset:0 sc1
buffer_load_dwordx4 v[116:119], v19, s[32:35], s57 offen offset:1024 sc1
buffer_load_dwordx4 v[120:123], v19, s[32:35], s57 offen offset:2048 sc1
buffer_load_dwordx4 v[124:127], v19, s[32:35], s57 offen offset:3072 sc1
buffer_load_dwordx4 v[128:131], v19, s[32:35], s58 offen offset:0 sc1
buffer_load_dwordx4 v[132:135], v19, s[32:35], s58 offen offset:1024 sc1
s_waitcnt vmcnt(0)
v_bitop3_b32 v97, s29, v97, v99 bitop3:0x7e
v_bitop3_b32 v101, s29, v101, v103 bitop3:0x7e
v_bitop3_b32 v105, s29, v105, v107 bitop3:0x7e
v_bitop3_b32 v109, s29, v109, v111 bitop3:0x7e
v_bitop3_b32 v113, s29, v113, v115 bitop3:0x7e
v_bitop3_b32 v117, s29, v117, v119 bitop3:0x7e
v_bitop3_b32 v121, s29, v121, v123 bitop3:0x7e
v_bitop3_b32 v125, s29, v125, v127 bitop3:0x7e
v_bitop3_b32 v129, s29, v129, v131 bitop3:0x7e
v_bitop3_b32 v133, s29, v133, v135 bitop3:0x7e
v_or3_b32 v97, v97, v101, v105
v_or3_b32 v109, v109, v113, v117
v_or3_b32 v121, v121, v125, v129
v_or3_b32 v133, v133, v97, v109
v_or_b32 v121, v121, v133
v_cmp_ne_u32 vcc, 0, v121
s_cbranch_vccz L_p2_ok
s_sleep 16
s_sub_u32 s50, s50, 1
s_cbranch_scc0 L_p2
L_p2_ok:
v_add_f32 v96, v96, v100
v_add_f32 v98, v98, v102
v_add_f32 v104, v104, v108
v_add_f32 v106, v106, v110
v_add_f32 v112, v112, v116
v_add_f32 v114, v114, v118
v_add_f32 v120, v120, v124
v_add_f32 v122, v122, v126
v_add_f32 v128, v128, v132
v_add_f32 v130, v130, v134
v_add_f32 v96, v96, v104
v_add_f32 v98, v98, v106
v_add_f32 v112, v112, v120
v_add_f32 v114, v114, v122
v_add_f32 v96, v96, v128
v_add_f32 v98, v98, v130
v_add_f32 v96, v96, v112
v_add_f32 v98, v98, v114
v_cvt_pk_bf16_f32 v96, v96, v98
v_mov_b32 v97, v96
v_mov_b32 v98, v96
v_mov_b32_dpp v97, v96 row_shr:4 row_mask:0xf bank_mask:0xa
v_mov_b32_dpp v98, v96 row_shl:4 row_mask:0xf bank_mask:0x5
v_lshlrev_b32 v100, 16, v97
v_and_b32 v101, 0xffff0000, v97
v_lshlrev_b32 v102, 16, v98
v_and_b32 v103, 0xffff0000, v98
v_mul_f32 v104, 0xbfb8aa3b, v100
v_mul_f32 v105, 0xbfb8aa3b, v101
v_exp_f32 v104, v104
v_exp_f32 v105, v105
v_add_f32 v104, 1.0, v104
v_add_f32 v105, 1.0, v105
v_rcp_f32 v104, v104
v_rcp_f32 v105, v105
v_mul_f32 v100, v100, v104
v_mul_f32 v101, v101, v105
v_cvt_pk_bf16_f32 v97, v100, v101
v_lshlrev_b32 v100, 16, v97
v_and_b32 v101, 0xffff0000, v97
v_mul_f32 v100, v100, v102
v_mul_f32 v101, v101, v103
v_cvt_pk_bf16_f32 v8, v100, v100
v_cvt_pk_bf16_f32 v9, v101, v101
s_add_u32 s52, s52, 61440
v_and_b32_dpp v20, v8, v4 quad_perm:[0,0,0,0] row_mask:0xf bank_mask:0xf
v_and_b32_dpp v21, v8, v5 quad_perm:[0,0,0,0] row_mask:0xf bank_mask:0xf
v_and_b32_dpp v22, v8, v6 quad_perm:[0,0,0,0] row_mask:0xf bank_mask:0xf
v_and_b32_dpp v23, v8, v7 quad_perm:[0,0,0,0] row_mask:0xf bank_mask:0xf
v_and_b32_dpp v24, v9, v4 quad_perm:[0,0,0,0] row_mask:0xf bank_mask:0xf
v_and_b32_dpp v25, v9, v5 quad_perm:[0,0,0,0] row_mask:0xf bank_mask:0xf
v_and_b32_dpp v26, v9, v6 quad_perm:[0,0,0,0] row_mask:0xf bank_mask:0xf
v_and_b32_dpp v27, v9, v7 quad_perm:[0,0,0,0] row_mask:0xf bank_mask:0xf
v_mfma_f32_16x16x32_bf16 v[28:31], v[20:23], v[48:51], 0
v_and_b32_dpp v20, v8, v4 quad_perm:[1,1,1,1] row_mask:0xf bank_mask:0xf
v_and_b32_dpp v21, v8, v5 quad_perm:[1,1,1,1] row_mask:0xf bank_mask:0xf
v_and_b32_dpp v22, v8, v6 quad_perm:[1,1,1,1] row_mask:0xf bank_mask:0xf
v_and_b32_dpp v23, v8, v7 quad_perm:[1,1,1,1] row_mask:0xf bank_mask:0xf
v_mfma_f32_16x16x32_bf16 v[28:31], v[24:27], v[52:55], v[28:31]
v_and_b32_dpp v24, v9, v4 quad_perm:[1,1,1,1] row_mask:0xf bank_mask:0xf
v_and_b32_dpp v25, v9, v5 quad_perm:[1,1,1,1] row_mask:0xf bank_mask:0xf
v_and_b32_dpp v26, v9, v6 quad_perm:[1,1,1,1] row_mask:0xf bank_mask:0xf
v_and_b32_dpp v27, v9, v7 quad_perm:[1,1,1,1] row_mask:0xf bank_mask:0xf
v_mfma_f32_16x16x32_bf16 v[28:31], v[20:23], v[56:59], v[28:31]
v_and_b32_dpp v20, v8, v4 quad_perm:[2,2,2,2] row_mask:0xf bank_mask:0xf
v_and_b32_dpp v21, v8, v5 quad_perm:[2,2,2,2] row_mask:0xf bank_mask:0xf
v_and_b32_dpp v22, v8, v6 quad_perm:[2,2,2,2] row_mask:0xf bank_mask:0xf
v_and_b32_dpp v23, v8, v7 quad_perm:[2,2,2,2] row_mask:0xf bank_mask:0xf
v_mfma_f32_16x16x32_bf16 v[28:31], v[24:27], v[60:63], v[28:31]
v_and_b32_dpp v24, v9, v4 quad_perm:[2,2,2,2] row_mask:0xf bank_mask:0xf
v_and_b32_dpp v25, v9, v5 quad_perm:[2,2,2,2] row_mask:0xf bank_mask:0xf
v_and_b32_dpp v26, v9, v6 quad_perm:[2,2,2,2] row_mask:0xf bank_mask:0xf
v_and_b32_dpp v27, v9, v7 quad_perm:[2,2,2,2] row_mask:0xf bank_mask:0xf
v_mfma_f32_16x16x32_bf16 v[28:31], v[20:23], v[64:67], v[28:31]
v_and_b32_dpp v20, v8, v4 quad_perm:[3,3,3,3] row_mask:0xf bank_mask:0xf
v_and_b32_dpp v21, v8, v5 quad_perm:[3,3,3,3] row_mask:0xf bank_mask:0xf
v_and_b32_dpp v22, v8, v6 quad_perm:[3,3,3,3] row_mask:0xf bank_mask:0xf
v_and_b32_dpp v23, v8, v7 quad_perm:[3,3,3,3] row_mask:0xf bank_mask:0xf
v_mfma_f32_16x16x32_bf16 v[28:31], v[24:27], v[68:71], v[28:31]
v_and_b32_dpp v24, v9, v4 quad_perm:[3,3,3,3] row_mask:0xf bank_mask:0xf
v_and_b32_dpp v25, v9, v5 quad_perm:[3,3,3,3] row_mask:0xf bank_mask:0xf
v_and_b32_dpp v26, v9, v6 quad_perm:[3,3,3,3] row_mask:0xf bank_mask:0xf
v_and_b32_dpp v27, v9, v7 quad_perm:[3,3,3,3] row_mask:0xf bank_mask:0xf
v_mfma_f32_16x16x32_bf16 v[28:31], v[20:23], v[72:75], v[28:31]
s_nop 0
v_mfma_f32_16x16x32_bf16 v[28:31], v[24:27], v[76:79], v[28:31]
v_lshrrev_b32 v34, 1, v18
v_lshrrev_b32 v3, 1, v1
v_lshlrev_b32 v3, 2, v3
v_add_u32 v3, 2048, v3
v_mov_b32 v10, 1.0
v_mov_b32 v11, 1.0
s_nop 1
v_permlane32_swap_b32 v28, v30
v_permlane32_swap_b32 v29, v31
s_nop 0
v_add_f32_dpp v28, v30, v28 row_ror:8 row_mask:0xf bank_mask:0xf
v_add_f32_dpp v29, v31, v29 row_ror:8 row_mask:0xf bank_mask:0xf
s_mov_b64 exec, s[14:15]
ds_write_b64 v34, v[28:29] offset:2048
s_mov_b32 exec_lo, 0x55555555
s_mov_b32 exec_hi, 0x55555555
ds_read2_b32 v[10:11], v3 offset1:32
s_mov_b64 exec, -1
s_mov_b32 s50, 131072
L_pr:
s_load_dwordx2 s[92:93], s[26:27], s52 glc
s_waitcnt lgkmcnt(0)
s_xor_b32 s92, s92, s29
s_xor_b32 s93, s93, s29
s_or_b32 s92, s92, s93
s_cbranch_scc0 L_wo
s_sleep 4
s_sub_u32 s50, s50, 1
s_cbranch_scc0 L_pr
L_wo:
s_cmpk_ge_u32 s2, 240
s_cbranch_scc1 L_help_end
s_lshl_b32 s53, s66, 2
s_add_u32 s53, s53, s28
s_mul_i32 s51, s53, 86
s_lshr_b32 s51, s51, 8
s_mul_i32 s51, s51, 21
s_add_u32 s53, s53, s51
s_and_b32 s51, s2, 7
s_mul_i32 s51, s51, 3
s_add_u32 s53, s53, s51
s_mul_i32 s51, s53, 81920
s_lshl_b32 s58, s49, 7
s_add_u32 s51, s51, s58
s_mov_b64 s[40:41], s[12:13]
s_mov_b32 s42, 7864320
s_mov_b32 s43, 0x20000
s_mov_b64 s[44:45], s[22:23]
s_mov_b32 s46, 1280
s_mov_b32 s47, 0x20000
v_mul_u32_u24 v2, 10240, v45
v_lshl_add_u32 v2, v46, 4, v2
s_lshl_b32 s56, s53, 12
s_add_u32 s56, s56, 65536
s_lshl_b32 s57, s49, 11
s_add_u32 s57, s57, 40960
v_lshrrev_b32 v37, 1, v18
s_lshl_b32 s53, s28, 8
v_add_u32 v37, s53, v37
v_lshrrev_b32 v36, 1, v1
v_lshlrev_b32 v36, 2, v36
v_add_u32 v36, 1024, v36
v_bfe_u32 v16, v1, 2, 3
v_lshlrev_b32 v16, 4, v16
v_lshrrev_b32 v17, 5, v1
v_lshl_add_u32 v16, v17, 3, v16
v_and_b32 v17, 2, v1
v_add_u32 v16, v16, v17
v_lshlrev_b32 v17, 3, v1
s_add_u32 s67, s29, 16
s_mov_b32 s24, 0x55555555
s_mov_b32 s25, s24
v_mov_b32 v40, 1.0
v_mov_b32 v41, 1.0
v_mov_b32 v42, 0x40370000
v_mov_b32 v43, 0x40380000
v_add_u32 v3, s58, v16
s_mov_b32 s50, 8388608
L_gk4:
ds_read_b32 v47, v44 offset:28
ds_read_u16 v14, v3 offset:9728
ds_read_u16 v15, v3 offset:9732
s_waitcnt lgkmcnt(0)
v_cmp_ne_u32 vcc, 8, v47
s_cbranch_vccz L_gk4_ok
s_sleep 1
s_sub_u32 s50, s50, 1
s_cbranch_scc0 L_gk4
L_gk4_ok:
buffer_load_dwordx4 v[48:51], v2, s[40:43], s51 offen nt
s_addk_i32 s51, 1280
buffer_load_dwordx4 v[52:55], v2, s[40:43], s51 offen nt
s_addk_i32 s51, 1280
s_mov_b32 s50, 8388608
L_gv:
ds_read_b32 v47, v44 offset:32
s_waitcnt lgkmcnt(0)
v_cmp_ne_u32 vcc, 8, v47
s_cbranch_vccz L_gv_ok
s_sleep 1
s_sub_u32 s50, s50, 1
s_cbranch_scc0 L_gv
L_gv_ok:
buffer_load_dwordx4 v[56:59], v2, s[40:43], s51 offen nt
s_addk_i32 s51, 1280
buffer_load_dwordx4 v[60:63], v2, s[40:43], s51 offen nt
s_addk_i32 s51, 1280
buffer_load_dwordx4 v[64:67], v2, s[40:43], s51 offen nt
s_addk_i32 s51, 1280
buffer_load_dwordx4 v[68:71], v2, s[40:43], s51 offen nt
s_addk_i32 s51, 1280
buffer_load_dwordx4 v[72:75], v2, s[40:43], s51 offen nt
s_addk_i32 s51, 1280
buffer_load_dwordx4 v[76:79], v2, s[40:43], s51 offen nt
s_cmp_lg_u32 s28, 3
s_cbranch_scc1 L_nof3
v_cvt_f64_f32 v[80:81], v10
v_cvt_f64_f32 v[82:83], v11
buffer_atomic_add_f64 v[80:81], v17, s[32:35], s57 offen offset:1024 sc1
buffer_atomic_add_f64 v[82:83], v17, s[32:35], s57 offen offset:1536 sc1
L_nof3:
s_mov_b32 s50, 8388608
L_go:
ds_read_b32 v47, v44 offset:40
s_waitcnt lgkmcnt(0)
v_cmp_ne_u32 vcc, 7, v47
s_cbranch_vccz L_go_ok
s_sleep 1
s_sub_u32 s50, s50, 1
s_cbranch_scc0 L_go
L_go_ok:
v_mov_b32 v47, 1
s_mov_b32 s50, 131072
buffer_load_dwordx4 v[96:99], v19, s[32:35], s56 offen offset:0 sc1
buffer_load_dwordx4 v[100:103], v19, s[32:35], s56 offen offset:1024 sc1
buffer_load_dwordx4 v[104:107], v19, s[32:35], s56 offen offset:2048 sc1
buffer_load_dwordx4 v[108:111], v19, s[32:35], s56 offen offset:3072 sc1
L_p4:
s_waitcnt vmcnt(0)
v_bitop3_b32 v112, s67, v97, v99 bitop3:0x7e
v_bitop3_b32 v113, s67, v101, v103 bitop3:0x7e
v_bitop3_b32 v114, s67, v105, v107 bitop3:0x7e
v_bitop3_b32 v115, s67, v109, v111 bitop3:0x7e
v_or3_b32 v116, v112, v113, v114
v_or_b32 v116, v115, v116
v_cmp_lt_u32 vcc, 0, v116
v_add_f32 v116, v96, v100
v_add_f32 v117, v98, v102
v_add_f32 v118, v104, v108
v_add_f32 v119, v106, v110
s_cbranch_vccz L_p4_ok
v_cmp_lt_u32 s[92:93], 0, v112
v_cmp_lt_u32 s[94:95], 0, v113
v_cmp_lt_u32 s[96:97], 0, v114
v_cmp_lt_u32 s[98:99], 0, v115
s_mov_b64 exec, s[92:93]
s_cbranch_execz L_p4_s0
buffer_load_dwordx4 v[96:99], v19, s[32:35], s56 offen offset:0 sc1
L_p4_s0:
s_mov_b64 exec, s[94:95]
s_cbranch_execz L_p4_s1
buffer_load_dwordx4 v[100:103], v19, s[32:35], s56 offen offset:1024 sc1
L_p4_s1:
s_mov_b64 exec, s[96:97]
s_cbranch_execz L_p4_s2
buffer_load_dwordx4 v[104:107], v19, s[32:35], s56 offen offset:2048 sc1
L_p4_s2:
s_mov_b64 exec, s[98:99]
s_cbranch_execz L_p4_s3
buffer_load_dwordx4 v[108:111], v19, s[32:35], s56 offen offset:3072 sc1
L_p4_s3:
s_mov_b64 exec, -1
s_sub_u32 s50, s50, 1
s_cbranch_scc0 L_p4
s_waitcnt vmcnt(0)
L_p4_ok:
v_pk_add_f32 v[116:117], v[116:117], v[118:119]
s_nop 1
v_add_f32_dpp v118, v116, v116 row_shl:4 row_mask:0xf bank_mask:0x5
v_add_f32_dpp v119, v117, v117 row_shl:4 row_mask:0xf bank_mask:0x5
v_add_f32_dpp v118, v116, v116 row_shr:4 row_mask:0xf bank_mask:0xa
v_add_f32_dpp v119, v117, v117 row_shr:4 row_mask:0xf bank_mask:0xa
v_cvt_pk_bf16_f32 v8, v118, v118
v_cvt_pk_bf16_f32 v9, v119, v119
s_nop 0
v_and_b32_dpp v20, v8, v4 quad_perm:[0,0,0,0] row_mask:0xf bank_mask:0xf
v_and_b32_dpp v21, v8, v5 quad_perm:[0,0,0,0] row_mask:0xf bank_mask:0xf
v_and_b32_dpp v22, v8, v6 quad_perm:[0,0,0,0] row_mask:0xf bank_mask:0xf
v_and_b32_dpp v23, v8, v7 quad_perm:[0,0,0,0] row_mask:0xf bank_mask:0xf
v_and_b32_dpp v24, v9, v4 quad_perm:[0,0,0,0] row_mask:0xf bank_mask:0xf
v_and_b32_dpp v25, v9, v5 quad_perm:[0,0,0,0] row_mask:0xf bank_mask:0xf
v_and_b32_dpp v26, v9, v6 quad_perm:[0,0,0,0] row_mask:0xf bank_mask:0xf
v_and_b32_dpp v27, v9, v7 quad_perm:[0,0,0,0] row_mask:0xf bank_mask:0xf
v_mfma_f32_16x16x32_bf16 v[28:31], v[20:23], v[48:51], 0
v_and_b32_dpp v20, v8, v4 quad_perm:[1,1,1,1] row_mask:0xf bank_mask:0xf
v_and_b32_dpp v21, v8, v5 quad_perm:[1,1,1,1] row_mask:0xf bank_mask:0xf
v_and_b32_dpp v22, v8, v6 quad_perm:[1,1,1,1] row_mask:0xf bank_mask:0xf
v_and_b32_dpp v23, v8, v7 quad_perm:[1,1,1,1] row_mask:0xf bank_mask:0xf
v_mfma_f32_16x16x32_bf16 v[28:31], v[24:27], v[52:55], v[28:31]
v_and_b32_dpp v24, v9, v4 quad_perm:[1,1,1,1] row_mask:0xf bank_mask:0xf
v_and_b32_dpp v25, v9, v5 quad_perm:[1,1,1,1] row_mask:0xf bank_mask:0xf
v_and_b32_dpp v26, v9, v6 quad_perm:[1,1,1,1] row_mask:0xf bank_mask:0xf
v_and_b32_dpp v27, v9, v7 quad_perm:[1,1,1,1] row_mask:0xf bank_mask:0xf
v_mfma_f32_16x16x32_bf16 v[28:31], v[20:23], v[56:59], v[28:31]
v_and_b32_dpp v20, v8, v4 quad_perm:[2,2,2,2] row_mask:0xf bank_mask:0xf
v_and_b32_dpp v21, v8, v5 quad_perm:[2,2,2,2] row_mask:0xf bank_mask:0xf
v_and_b32_dpp v22, v8, v6 quad_perm:[2,2,2,2] row_mask:0xf bank_mask:0xf
v_and_b32_dpp v23, v8, v7 quad_perm:[2,2,2,2] row_mask:0xf bank_mask:0xf
v_mfma_f32_16x16x32_bf16 v[28:31], v[24:27], v[60:63], v[28:31]
v_and_b32_dpp v24, v9, v4 quad_perm:[2,2,2,2] row_mask:0xf bank_mask:0xf
v_and_b32_dpp v25, v9, v5 quad_perm:[2,2,2,2] row_mask:0xf bank_mask:0xf
v_and_b32_dpp v26, v9, v6 quad_perm:[2,2,2,2] row_mask:0xf bank_mask:0xf
v_and_b32_dpp v27, v9, v7 quad_perm:[2,2,2,2] row_mask:0xf bank_mask:0xf
v_mfma_f32_16x16x32_bf16 v[28:31], v[20:23], v[64:67], v[28:31]
v_and_b32_dpp v20, v8, v4 quad_perm:[3,3,3,3] row_mask:0xf bank_mask:0xf
v_and_b32_dpp v21, v8, v5 quad_perm:[3,3,3,3] row_mask:0xf bank_mask:0xf
v_and_b32_dpp v22, v8, v6 quad_perm:[3,3,3,3] row_mask:0xf bank_mask:0xf
v_and_b32_dpp v23, v8, v7 quad_perm:[3,3,3,3] row_mask:0xf bank_mask:0xf
v_mfma_f32_16x16x32_bf16 v[28:31], v[24:27], v[68:71], v[28:31]
v_and_b32_dpp v24, v9, v4 quad_perm:[3,3,3,3] row_mask:0xf bank_mask:0xf
v_and_b32_dpp v25, v9, v5 quad_perm:[3,3,3,3] row_mask:0xf bank_mask:0xf
v_and_b32_dpp v26, v9, v6 quad_perm:[3,3,3,3] row_mask:0xf bank_mask:0xf
v_and_b32_dpp v27, v9, v7 quad_perm:[3,3,3,3] row_mask:0xf bank_mask:0xf
v_mfma_f32_16x16x32_bf16 v[28:31], v[20:23], v[72:75], v[28:31]
s_nop 0
v_mfma_f32_16x16x32_bf16 v[28:31], v[24:27], v[76:79], v[28:31]
s_nop 7
v_permlane32_swap_b32 v28, v30
v_permlane32_swap_b32 v29, v31
s_nop 0
v_add_f32_dpp v28, v30, v28 row_ror:8 row_mask:0xf bank_mask:0xf
v_add_f32_dpp v29, v31, v29 row_ror:8 row_mask:0xf bank_mask:0xf
s_mov_b64 exec, s[14:15]
ds_write_b64 v37, v[28:29] offset:1024
s_mov_b64 exec, 1
ds_add_rtn_u32 v47, v44, v47 offset:36
s_mov_b64 exec, s[24:25]
ds_read2_b32 v[20:21], v36 offset0:0 offset1:32
ds_read2_b32 v[22:23], v36 offset0:64 offset1:96
ds_read2_b32 v[24:25], v36 offset0:128 offset1:160
ds_read2_b32 v[26:27], v36 offset0:192 offset1:224
s_waitcnt lgkmcnt(0)
v_readfirstlane_b32 s51, v47
v_pk_add_f32 v[20:21], v[20:21], v[22:23]
v_pk_add_f32 v[24:25], v[24:25], v[26:27]
s_cmp_lg_u32 s51, 3
s_cbranch_scc1 L_help_end
v_pk_add_f32 v[40:41], v[20:21], v[24:25]
s_mov_b64 exec, -1
buffer_load_dwordx2 v[84:85], v17, s[32:35], s57 offen offset:1024 sc1
buffer_load_dwordx2 v[86:87], v17, s[32:35], s57 offen offset:1536 sc1
v_cvt_f64_f32 v[88:89], v40
v_cvt_f64_f32 v[90:91], v41
buffer_atomic_add_f64 v[88:89], v17, s[32:35], s57 offen sc0 sc1
buffer_atomic_add_f64 v[90:91], v17, s[32:35], s57 offen offset:512 sc0 sc1
v_cvt_f64_f32 v[92:93], v40
v_cvt_f64_f32 v[94:95], v41
v_lshlrev_b32 v14, 16, v14
v_lshlrev_b32 v15, 16, v15
s_mov_b32 s50, 131072
s_waitcnt vmcnt(2)
v_cvt_f32_f64 v12, v[84:85]
v_cvt_f32_f64 v13, v[86:87]
v_cmp_ne_u32 s[94:95], v85, v43
v_cmp_ne_u32 s[96:97], v87, v43
v_cvt_pk_bf16_f32 v22, v12, v13
v_lshlrev_b32 v12, 16, v22
v_and_b32 v13, 0xffff0000, v22
v_mul_f32 v24, 0xbfb8aa3b, v12
v_mul_f32 v25, 0xbfb8aa3b, v13
v_exp_f32 v24, v24
v_exp_f32 v25, v25
v_add_f32 v24, 1.0, v24
v_add_f32 v25, 1.0, v25
v_rcp_f32 v24, v24
v_rcp_f32 v25, v25
v_mul_f32 v12, v12, v24
v_mul_f32 v13, v13, v25
s_or_b64 s[94:95], s[94:95], s[96:97]
v_cvt_pk_bf16_f32 v22, v12, v13
s_andn2_b64 s[94:95], s[94:95], s[24:25]
v_lshlrev_b32 v12, 16, v22
v_and_b32 v13, 0xffff0000, v22
s_cmp_lg_u64 s[94:95], 0
s_cbranch_scc1 L_glate
s_waitcnt vmcnt(0)
v_add_f64 v[92:93], v[92:93], v[88:89]
v_add_f64 v[94:95], v[94:95], v[90:91]
v_cmp_eq_u32 vcc, v89, v42
v_cmp_eq_u32 s[92:93], v91, v42
v_cvt_f32_f64 v20, v[92:93]
v_cvt_f32_f64 v21, v[94:95]
s_lshr_b64 vcc, vcc, 1
s_lshr_b64 s[92:93], s[92:93], 1
v_cvt_pk_bf16_f32 v23, v20, v21
L_gok:
v_lshlrev_b32 v20, 16, v23
v_and_b32 v21, 0xffff0000, v23
v_pk_mul_f32 v[20:21], v[20:21], v[12:13]
v_cvt_pk_bf16_f32 v22, v20, v21
v_lshlrev_b32 v20, 16, v22
v_and_b32 v21, 0xffff0000, v22
v_pk_add_f32 v[20:21], v[20:21], v[14:15]
v_cvt_pk_bf16_f32 v22, v20, v21
s_and_b64 exec, vcc, s[24:25]
s_cbranch_execz L_no0
buffer_store_short v22, v16, s[44:47], s58 offen
L_no0:
s_and_b64 exec, s[92:93], s[24:25]
s_cbranch_execz L_no1
buffer_store_short_d16_hi v22, v16, s[44:47], s58 offen offset:4
s_cmp_lg_u32 s49, 0
s_cbranch_scc1 L_no1
s_and_b64 exec, exec, 1
s_cbranch_execz L_no1
v_mov_b32 v49, s29
buffer_store_dword v49, v44, s[32:35], 0 offen
L_no1:
L_help_end:
L_end:
s_endpgm
L_glate:
s_waitcnt vmcnt(0)
v_add_f64 v[92:93], v[92:93], v[88:89]
v_add_f64 v[94:95], v[94:95], v[90:91]
v_cmp_eq_u32 vcc, v89, v42
v_cmp_eq_u32 s[92:93], v91, v42
v_cvt_f32_f64 v20, v[92:93]
v_cvt_f32_f64 v21, v[94:95]
s_lshr_b64 vcc, vcc, 1
s_lshr_b64 s[92:93], s[92:93], 1
v_cvt_pk_bf16_f32 v23, v20, v21
s_or_b64 s[96:97], vcc, s[92:93]
s_and_b64 s[96:97], s[96:97], s[24:25]
s_cbranch_scc0 L_help_end
L_gre:
buffer_load_dwordx2 v[84:85], v17, s[32:35], s57 offen offset:1024 sc1
buffer_load_dwordx2 v[86:87], v17, s[32:35], s57 offen offset:1536 sc1
s_waitcnt vmcnt(0)
v_cvt_f32_f64 v12, v[84:85]
v_cvt_f32_f64 v13, v[86:87]
v_cmp_ne_u32 s[94:95], v85, v43
v_cmp_ne_u32 s[96:97], v87, v43
v_cvt_pk_bf16_f32 v22, v12, v13
v_lshlrev_b32 v12, 16, v22
v_and_b32 v13, 0xffff0000, v22
v_mul_f32 v24, 0xbfb8aa3b, v12
v_mul_f32 v25, 0xbfb8aa3b, v13
v_exp_f32 v24, v24
v_exp_f32 v25, v25
v_add_f32 v24, 1.0, v24
v_add_f32 v25, 1.0, v25
v_rcp_f32 v24, v24
v_rcp_f32 v25, v25
v_mul_f32 v12, v12, v24
v_mul_f32 v13, v13, v25
s_or_b64 s[94:95], s[94:95], s[96:97]
v_cvt_pk_bf16_f32 v22, v12, v13
s_andn2_b64 s[94:95], s[94:95], s[24:25]
v_lshlrev_b32 v12, 16, v22
v_and_b32 v13, 0xffff0000, v22
s_cmp_eq_u64 s[94:95], 0
s_cbranch_scc1 L_gok
s_sub_u32 s50, s50, 1
s_cbranch_scc0 L_gre
s_endpgm
L_code_end:
.section .rodata,"a"
.p2align 6
.amdhsa_kernel recurrent_scan__sliding_block_cached__glu_gated_swiglu__decode_kernel
  .amdhsa_next_free_vgpr 168
  .amdhsa_next_free_sgpr 100
  .amdhsa_accum_offset 168
  .amdhsa_group_segment_fixed_size 0
  .amdhsa_kernarg_size 96
  .amdhsa_user_sgpr_count 2
  .amdhsa_user_sgpr_kernarg_segment_ptr 1
  .amdhsa_system_sgpr_workgroup_id_x 1
  .amdhsa_float_denorm_mode_32 3
.end_amdhsa_kernel
```
